```python
import torch

def _softmax(x, axis=-1):
    return torch.softmax(x, dim=axis)
def _gelu(x):
    return torch.nn.functional.gelu(x, approximate="tanh")
def _silu(x):
    return torch.nn.functional.silu(x)
def _sigmoid(x):
    return torch.sigmoid(x)
def _layernorm(x, axis=-1, eps=1e-5):
    m = x.mean(dim=axis, keepdim=True)
    v = x.var(dim=axis, keepdim=True, unbiased=False)
    return (x - m) / torch.sqrt(v + eps)
def _scatter_add(tgt, idx, src, axis=0):
    return tgt.clone().index_add_(axis, idx, src)
def _segment_sum(src, seg, n):
    out = torch.zeros((n,) + src.shape[1:], dtype=src.dtype)
    return out.index_add_(0, seg, src)
def _pad(x, pw):
    flat = tuple(v for pair in reversed(pw) for v in pair)
    return torch.nn.functional.pad(x, flat)

kernel_name = 'parallel_sum__sliding_local_dilated__glu_gated_reglu__prompt'

def setup_inputs():

    _w = (lambda a: (lambda t: t.to(torch.bfloat16) if t.is_floating_point() else t)(torch.as_tensor(a)))
    def _A_setup():
        B, S, D = 1, 2048, 576
        return {
            "x": _w((lambda *s: torch.randn(*s, dtype=torch.bfloat16) * 0.05)(B, S, D)),
            "wqkv": _w((lambda *s: torch.randn(*s, dtype=torch.bfloat16) * 0.05)(D, 3 * D)),
            "wo": _w((lambda *s: torch.randn(*s, dtype=torch.bfloat16) * 0.05)(D, D)),
        }
    _A_in = _A_setup()

    def _B_setup():
        B, S, D, F = 1, 2048, 576, 4608
        return {
            "x": _w((lambda *s: torch.randn(*s, dtype=torch.bfloat16) * 0.05)(B, S, D)),
            "W_gate": _w((lambda *s: torch.randn(*s, dtype=torch.bfloat16) * 0.8)(D, F) * (2.0 / D) ** 0.5),
            "W_up": _w((lambda *s: torch.randn(*s, dtype=torch.bfloat16) * 0.8)(D, F) * (2.0 / D) ** 0.5),
            "W_down": _w((lambda *s: torch.randn(*s, dtype=torch.bfloat16) * 0.8)(F, D) * (1.0 / F) ** 0.5),
        }
    _B_in = _B_setup()

    return {
        "A_x": _A_in["x"],
        "A_wqkv": _A_in["wqkv"],
        "A_wo": _A_in["wo"],
        "B_x": _B_in["x"],
        "B_W_gate": _B_in["W_gate"],
        "B_W_up": _B_in["W_up"],
        "B_W_down": _B_in["W_down"],
    }

def reference(A_x, A_wqkv, A_wo, B_x, B_W_gate, B_W_up, B_W_down):
    def _A_ref(x, wqkv, wo):
        B, S, D = x.shape
        H = 32; Dh = D // H
        W, dil = 8, 2
        qkv = (lambda x, *d: x.permute(*d))((x @ wqkv).reshape(B, S, 3, H, Dh), 2, 0, 3, 1, 4)
        q, k, v = qkv[0], qkv[1], qkv[2]
        scale = Dh ** -0.5
        pos = torch.arange(S)
        off = torch.arange(W) * dil
        idx = pos[:, None] - off[None, :]
        mask = idx >= 0
        idx_c = torch.where(mask, idx, 0).reshape(-1)
        kg = k[:, :, idx_c, :].reshape(B, H, S, W, Dh)
        vg = v[:, :, idx_c, :].reshape(B, H, S, W, Dh)
        logits = torch.einsum("bhsd,bhswd->bhsw", q, kg) * scale
        logits = torch.where(mask[None, None, :, :], logits, -1e9)
        attn = _softmax(logits, axis=-1)
        o = torch.einsum("bhsw,bhswd->bhsd", attn, vg)
        return (lambda x, *d: x.permute(*d))(o, 0, 2, 1, 3).reshape(B, S, D) @ wo

    def _B_ref(x, W_gate, W_up, W_down):
        gate = torch.einsum("bsd,df->bsf", x, W_gate)
        up = torch.einsum("bsd,df->bsf", x, W_up)
        gate = gate * (lambda x, dt: x.to(dt))(gate > 0, gate.dtype)
        h = gate * up
        return torch.einsum("bsf,fd->bsd", h, W_down)

    x = A_x
    xn = _layernorm(x, axis=-1)
    return x + _A_ref(xn, A_wqkv, A_wo) + _B_ref(xn, B_W_gate, B_W_up, B_W_down)
```

```asm
; @launch kernel=ln_kernel grid=(976,1,1) block=(64,1,1) lds=0
; @launch kernel=g1_kernel grid=(256,1,1) block=(512,1,1) lds=163840
; @launch kernel=g2_kernel grid=(256,1,1) block=(256,1,1) lds=147456
.amdgcn_target "amdgcn-amd-amdhsa--gfx950"
.text
.globl ln_kernel
.p2align 8
.type ln_kernel,@function
ln_kernel:
    s_cmp_ge_u32 s2, 256
    s_cbranch_scc1 RP_ROLE
    s_load_dwordx2 s[4:5], s[0:1], 0
    s_load_dwordx2 s[6:7], s[0:1], 72
    v_lshrrev_b32 v1, 3, v0
    v_and_b32 v2, 7, v0
    s_lshl_b32 s3, s2, 3
    v_add_u32 v1, s3, v1
    v_lshrrev_b32 v3, 2, v2
    v_and_b32 v4, 3, v2
    s_movk_i32 s16, 1152
    v_mul_lo_u32 v5, v1, s16
    v_lshl_add_u32 v5, v3, 6, v5
    v_lshl_add_u32 v5, v4, 3, v5
    v_lshlrev_b32 v6, 6, v1
    v_lshl_add_u32 v6, v4, 4, v6
    v_lshl_add_u32 v6, v3, 17, v6
    s_waitcnt lgkmcnt(0)

    s_mov_b32 s8, s4
    s_mov_b32 s9, s5
    s_mov_b32 s10, 0x240000
    s_mov_b32 s11, 0x00020000
    s_mov_b32 s12, s6
    s_mov_b32 s13, s7
    s_mov_b32 s14, 0x240000
    s_mov_b32 s15, 0x00020000
    buffer_load_dwordx2 v[8:9], v5, s[8:11], 0 offen offset:0
    buffer_load_dwordx2 v[10:11], v5, s[8:11], 0 offen offset:32
    buffer_load_dwordx2 v[12:13], v5, s[8:11], 0 offen offset:128
    buffer_load_dwordx2 v[14:15], v5, s[8:11], 0 offen offset:160
    buffer_load_dwordx2 v[16:17], v5, s[8:11], 0 offen offset:256
    buffer_load_dwordx2 v[18:19], v5, s[8:11], 0 offen offset:288
    buffer_load_dwordx2 v[20:21], v5, s[8:11], 0 offen offset:384
    buffer_load_dwordx2 v[22:23], v5, s[8:11], 0 offen offset:416
    buffer_load_dwordx2 v[24:25], v5, s[8:11], 0 offen offset:512
    buffer_load_dwordx2 v[26:27], v5, s[8:11], 0 offen offset:544
    buffer_load_dwordx2 v[28:29], v5, s[8:11], 0 offen offset:640
    buffer_load_dwordx2 v[30:31], v5, s[8:11], 0 offen offset:672
    buffer_load_dwordx2 v[32:33], v5, s[8:11], 0 offen offset:768
    buffer_load_dwordx2 v[34:35], v5, s[8:11], 0 offen offset:800
    buffer_load_dwordx2 v[36:37], v5, s[8:11], 0 offen offset:896
    buffer_load_dwordx2 v[38:39], v5, s[8:11], 0 offen offset:928
    buffer_load_dwordx2 v[40:41], v5, s[8:11], 0 offen offset:1024
    buffer_load_dwordx2 v[42:43], v5, s[8:11], 0 offen offset:1056
    v_mov_b32 v50, 0
    v_mov_b32 v51, 0
    s_waitcnt vmcnt(16)
    v_lshlrev_b32 v64, 16, v8
    v_and_b32 v65, 0xffff0000, v8
    v_add_f32 v50, v50, v64
    v_add_f32 v51, v51, v65
    v_lshlrev_b32 v66, 16, v9
    v_and_b32 v67, 0xffff0000, v9
    v_add_f32 v50, v50, v66
    v_add_f32 v51, v51, v67
    v_lshlrev_b32 v68, 16, v10
    v_and_b32 v69, 0xffff0000, v10
    v_add_f32 v50, v50, v68
    v_add_f32 v51, v51, v69
    v_lshlrev_b32 v70, 16, v11
    v_and_b32 v71, 0xffff0000, v11
    v_add_f32 v50, v50, v70
    v_add_f32 v51, v51, v71
    s_waitcnt vmcnt(14)
    v_lshlrev_b32 v72, 16, v12
    v_and_b32 v73, 0xffff0000, v12
    v_add_f32 v50, v50, v72
    v_add_f32 v51, v51, v73
    v_lshlrev_b32 v74, 16, v13
    v_and_b32 v75, 0xffff0000, v13
    v_add_f32 v50, v50, v74
    v_add_f32 v51, v51, v75
    v_lshlrev_b32 v76, 16, v14
    v_and_b32 v77, 0xffff0000, v14
    v_add_f32 v50, v50, v76
    v_add_f32 v51, v51, v77
    v_lshlrev_b32 v78, 16, v15
    v_and_b32 v79, 0xffff0000, v15
    v_add_f32 v50, v50, v78
    v_add_f32 v51, v51, v79
    s_waitcnt vmcnt(12)
    v_lshlrev_b32 v80, 16, v16
    v_and_b32 v81, 0xffff0000, v16
    v_add_f32 v50, v50, v80
    v_add_f32 v51, v51, v81
    v_lshlrev_b32 v82, 16, v17
    v_and_b32 v83, 0xffff0000, v17
    v_add_f32 v50, v50, v82
    v_add_f32 v51, v51, v83
    v_lshlrev_b32 v84, 16, v18
    v_and_b32 v85, 0xffff0000, v18
    v_add_f32 v50, v50, v84
    v_add_f32 v51, v51, v85
    v_lshlrev_b32 v86, 16, v19
    v_and_b32 v87, 0xffff0000, v19
    v_add_f32 v50, v50, v86
    v_add_f32 v51, v51, v87
    s_waitcnt vmcnt(10)
    v_lshlrev_b32 v88, 16, v20
    v_and_b32 v89, 0xffff0000, v20
    v_add_f32 v50, v50, v88
    v_add_f32 v51, v51, v89
    v_lshlrev_b32 v90, 16, v21
    v_and_b32 v91, 0xffff0000, v21
    v_add_f32 v50, v50, v90
    v_add_f32 v51, v51, v91
    v_lshlrev_b32 v92, 16, v22
    v_and_b32 v93, 0xffff0000, v22
    v_add_f32 v50, v50, v92
    v_add_f32 v51, v51, v93
    v_lshlrev_b32 v94, 16, v23
    v_and_b32 v95, 0xffff0000, v23
    v_add_f32 v50, v50, v94
    v_add_f32 v51, v51, v95
    s_waitcnt vmcnt(8)
    v_lshlrev_b32 v96, 16, v24
    v_and_b32 v97, 0xffff0000, v24
    v_add_f32 v50, v50, v96
    v_add_f32 v51, v51, v97
    v_lshlrev_b32 v98, 16, v25
    v_and_b32 v99, 0xffff0000, v25
    v_add_f32 v50, v50, v98
    v_add_f32 v51, v51, v99
    v_lshlrev_b32 v100, 16, v26
    v_and_b32 v101, 0xffff0000, v26
    v_add_f32 v50, v50, v100
    v_add_f32 v51, v51, v101
    v_lshlrev_b32 v102, 16, v27
    v_and_b32 v103, 0xffff0000, v27
    v_add_f32 v50, v50, v102
    v_add_f32 v51, v51, v103
    s_waitcnt vmcnt(6)
    v_lshlrev_b32 v104, 16, v28
    v_and_b32 v105, 0xffff0000, v28
    v_add_f32 v50, v50, v104
    v_add_f32 v51, v51, v105
    v_lshlrev_b32 v106, 16, v29
    v_and_b32 v107, 0xffff0000, v29
    v_add_f32 v50, v50, v106
    v_add_f32 v51, v51, v107
    v_lshlrev_b32 v108, 16, v30
    v_and_b32 v109, 0xffff0000, v30
    v_add_f32 v50, v50, v108
    v_add_f32 v51, v51, v109
    v_lshlrev_b32 v110, 16, v31
    v_and_b32 v111, 0xffff0000, v31
    v_add_f32 v50, v50, v110
    v_add_f32 v51, v51, v111
    s_waitcnt vmcnt(4)
    v_lshlrev_b32 v112, 16, v32
    v_and_b32 v113, 0xffff0000, v32
    v_add_f32 v50, v50, v112
    v_add_f32 v51, v51, v113
    v_lshlrev_b32 v114, 16, v33
    v_and_b32 v115, 0xffff0000, v33
    v_add_f32 v50, v50, v114
    v_add_f32 v51, v51, v115
    v_lshlrev_b32 v116, 16, v34
    v_and_b32 v117, 0xffff0000, v34
    v_add_f32 v50, v50, v116
    v_add_f32 v51, v51, v117
    v_lshlrev_b32 v118, 16, v35
    v_and_b32 v119, 0xffff0000, v35
    v_add_f32 v50, v50, v118
    v_add_f32 v51, v51, v119
    s_waitcnt vmcnt(2)
    v_lshlrev_b32 v120, 16, v36
    v_and_b32 v121, 0xffff0000, v36
    v_add_f32 v50, v50, v120
    v_add_f32 v51, v51, v121
    v_lshlrev_b32 v122, 16, v37
    v_and_b32 v123, 0xffff0000, v37
    v_add_f32 v50, v50, v122
    v_add_f32 v51, v51, v123
    v_lshlrev_b32 v124, 16, v38
    v_and_b32 v125, 0xffff0000, v38
    v_add_f32 v50, v50, v124
    v_add_f32 v51, v51, v125
    v_lshlrev_b32 v126, 16, v39
    v_and_b32 v127, 0xffff0000, v39
    v_add_f32 v50, v50, v126
    v_add_f32 v51, v51, v127
    s_waitcnt vmcnt(0)
    v_lshlrev_b32 v128, 16, v40
    v_and_b32 v129, 0xffff0000, v40
    v_add_f32 v50, v50, v128
    v_add_f32 v51, v51, v129
    v_lshlrev_b32 v130, 16, v41
    v_and_b32 v131, 0xffff0000, v41
    v_add_f32 v50, v50, v130
    v_add_f32 v51, v51, v131
    v_lshlrev_b32 v132, 16, v42
    v_and_b32 v133, 0xffff0000, v42
    v_add_f32 v50, v50, v132
    v_add_f32 v51, v51, v133
    v_lshlrev_b32 v134, 16, v43
    v_and_b32 v135, 0xffff0000, v43
    v_add_f32 v50, v50, v134
    v_add_f32 v51, v51, v135
    v_add_f32 v50, v50, v51
    s_nop 1
    v_add_f32_dpp v50, v50, v50 quad_perm:[1,0,3,2] row_mask:0xf bank_mask:0xf
    s_nop 1
    v_add_f32_dpp v50, v50, v50 quad_perm:[2,3,0,1] row_mask:0xf bank_mask:0xf
    s_nop 1
    v_add_f32_dpp v50, v50, v50 row_half_mirror row_mask:0xf bank_mask:0xf

    v_mul_f32 v50, 0x3ae38e39, v50
    v_mov_b32 v52, 0
    v_mov_b32 v53, 0
    v_sub_f32 v54, v64, v50
    v_sub_f32 v55, v65, v50
    v_fmac_f32 v52, v54, v54
    v_fmac_f32 v53, v55, v55
    v_sub_f32 v54, v66, v50
    v_sub_f32 v55, v67, v50
    v_fmac_f32 v52, v54, v54
    v_fmac_f32 v53, v55, v55
    v_sub_f32 v54, v68, v50
    v_sub_f32 v55, v69, v50
    v_fmac_f32 v52, v54, v54
    v_fmac_f32 v53, v55, v55
    v_sub_f32 v54, v70, v50
    v_sub_f32 v55, v71, v50
    v_fmac_f32 v52, v54, v54
    v_fmac_f32 v53, v55, v55
    v_sub_f32 v54, v72, v50
    v_sub_f32 v55, v73, v50
    v_fmac_f32 v52, v54, v54
    v_fmac_f32 v53, v55, v55
    v_sub_f32 v54, v74, v50
    v_sub_f32 v55, v75, v50
    v_fmac_f32 v52, v54, v54
    v_fmac_f32 v53, v55, v55
    v_sub_f32 v54, v76, v50
    v_sub_f32 v55, v77, v50
    v_fmac_f32 v52, v54, v54
    v_fmac_f32 v53, v55, v55
    v_sub_f32 v54, v78, v50
    v_sub_f32 v55, v79, v50
    v_fmac_f32 v52, v54, v54
    v_fmac_f32 v53, v55, v55
    v_sub_f32 v54, v80, v50
    v_sub_f32 v55, v81, v50
    v_fmac_f32 v52, v54, v54
    v_fmac_f32 v53, v55, v55
    v_sub_f32 v54, v82, v50
    v_sub_f32 v55, v83, v50
    v_fmac_f32 v52, v54, v54
    v_fmac_f32 v53, v55, v55
    v_sub_f32 v54, v84, v50
    v_sub_f32 v55, v85, v50
    v_fmac_f32 v52, v54, v54
    v_fmac_f32 v53, v55, v55
    v_sub_f32 v54, v86, v50
    v_sub_f32 v55, v87, v50
    v_fmac_f32 v52, v54, v54
    v_fmac_f32 v53, v55, v55
    v_sub_f32 v54, v88, v50
    v_sub_f32 v55, v89, v50
    v_fmac_f32 v52, v54, v54
    v_fmac_f32 v53, v55, v55
    v_sub_f32 v54, v90, v50
    v_sub_f32 v55, v91, v50
    v_fmac_f32 v52, v54, v54
    v_fmac_f32 v53, v55, v55
    v_sub_f32 v54, v92, v50
    v_sub_f32 v55, v93, v50
    v_fmac_f32 v52, v54, v54
    v_fmac_f32 v53, v55, v55
    v_sub_f32 v54, v94, v50
    v_sub_f32 v55, v95, v50
    v_fmac_f32 v52, v54, v54
    v_fmac_f32 v53, v55, v55
    v_sub_f32 v54, v96, v50
    v_sub_f32 v55, v97, v50
    v_fmac_f32 v52, v54, v54
    v_fmac_f32 v53, v55, v55
    v_sub_f32 v54, v98, v50
    v_sub_f32 v55, v99, v50
    v_fmac_f32 v52, v54, v54
    v_fmac_f32 v53, v55, v55
    v_sub_f32 v54, v100, v50
    v_sub_f32 v55, v101, v50
    v_fmac_f32 v52, v54, v54
    v_fmac_f32 v53, v55, v55
    v_sub_f32 v54, v102, v50
    v_sub_f32 v55, v103, v50
    v_fmac_f32 v52, v54, v54
    v_fmac_f32 v53, v55, v55
    v_sub_f32 v54, v104, v50
    v_sub_f32 v55, v105, v50
    v_fmac_f32 v52, v54, v54
    v_fmac_f32 v53, v55, v55
    v_sub_f32 v54, v106, v50
    v_sub_f32 v55, v107, v50
    v_fmac_f32 v52, v54, v54
    v_fmac_f32 v53, v55, v55
    v_sub_f32 v54, v108, v50
    v_sub_f32 v55, v109, v50
    v_fmac_f32 v52, v54, v54
    v_fmac_f32 v53, v55, v55
    v_sub_f32 v54, v110, v50
    v_sub_f32 v55, v111, v50
    v_fmac_f32 v52, v54, v54
    v_fmac_f32 v53, v55, v55
    v_sub_f32 v54, v112, v50
    v_sub_f32 v55, v113, v50
    v_fmac_f32 v52, v54, v54
    v_fmac_f32 v53, v55, v55
    v_sub_f32 v54, v114, v50
    v_sub_f32 v55, v115, v50
    v_fmac_f32 v52, v54, v54
    v_fmac_f32 v53, v55, v55
    v_sub_f32 v54, v116, v50
    v_sub_f32 v55, v117, v50
    v_fmac_f32 v52, v54, v54
    v_fmac_f32 v53, v55, v55
    v_sub_f32 v54, v118, v50
    v_sub_f32 v55, v119, v50
    v_fmac_f32 v52, v54, v54
    v_fmac_f32 v53, v55, v55
    v_sub_f32 v54, v120, v50
    v_sub_f32 v55, v121, v50
    v_fmac_f32 v52, v54, v54
    v_fmac_f32 v53, v55, v55
    v_sub_f32 v54, v122, v50
    v_sub_f32 v55, v123, v50
    v_fmac_f32 v52, v54, v54
    v_fmac_f32 v53, v55, v55
    v_sub_f32 v54, v124, v50
    v_sub_f32 v55, v125, v50
    v_fmac_f32 v52, v54, v54
    v_fmac_f32 v53, v55, v55
    v_sub_f32 v54, v126, v50
    v_sub_f32 v55, v127, v50
    v_fmac_f32 v52, v54, v54
    v_fmac_f32 v53, v55, v55
    v_sub_f32 v54, v128, v50
    v_sub_f32 v55, v129, v50
    v_fmac_f32 v52, v54, v54
    v_fmac_f32 v53, v55, v55
    v_sub_f32 v54, v130, v50
    v_sub_f32 v55, v131, v50
    v_fmac_f32 v52, v54, v54
    v_fmac_f32 v53, v55, v55
    v_sub_f32 v54, v132, v50
    v_sub_f32 v55, v133, v50
    v_fmac_f32 v52, v54, v54
    v_fmac_f32 v53, v55, v55
    v_sub_f32 v54, v134, v50
    v_sub_f32 v55, v135, v50
    v_fmac_f32 v52, v54, v54
    v_fmac_f32 v53, v55, v55
    v_add_f32 v52, v52, v53
    s_nop 1
    v_add_f32_dpp v52, v52, v52 quad_perm:[1,0,3,2] row_mask:0xf bank_mask:0xf
    s_nop 1
    v_add_f32_dpp v52, v52, v52 quad_perm:[2,3,0,1] row_mask:0xf bank_mask:0xf
    s_nop 1
    v_add_f32_dpp v52, v52, v52 row_half_mirror row_mask:0xf bank_mask:0xf

    v_mul_f32 v52, 0x3ae38e39, v52
    v_cvt_pk_bf16_f32 v54, v50, v52
    v_lshlrev_b32 v50, 16, v54
    v_and_b32 v52, 0xffff0000, v54
    v_add_f32 v52, 0x3727c5ac, v52
    v_cvt_pk_bf16_f32 v54, v52, v52
    v_lshlrev_b32 v52, 16, v54
    v_sqrt_f32 v52, v52
    s_nop 0
    v_cvt_pk_bf16_f32 v54, v52, v52
    v_lshlrev_b32 v52, 16, v54
    v_rcp_f32 v53, v52
    s_nop 0

    v_sub_f32 v54, v64, v50
    v_sub_f32 v55, v65, v50
    v_cvt_pk_bf16_f32 v56, v54, v55
    v_lshlrev_b32 v54, 16, v56
    v_and_b32 v55, 0xffff0000, v56
    v_mul_f32 v56, v54, v53
    v_mul_f32 v57, v55, v53
    v_fma_f32 v58, -v56, v52, v54
    v_fma_f32 v59, -v57, v52, v55
    v_fmac_f32 v56, v58, v53
    v_fmac_f32 v57, v59, v53
    v_cvt_pk_bf16_f32 v8, v56, v57

    v_sub_f32 v54, v66, v50
    v_sub_f32 v55, v67, v50
    v_cvt_pk_bf16_f32 v56, v54, v55
    v_lshlrev_b32 v54, 16, v56
    v_and_b32 v55, 0xffff0000, v56
    v_mul_f32 v56, v54, v53
    v_mul_f32 v57, v55, v53
    v_fma_f32 v58, -v56, v52, v54
    v_fma_f32 v59, -v57, v52, v55
    v_fmac_f32 v56, v58, v53
    v_fmac_f32 v57, v59, v53
    v_cvt_pk_bf16_f32 v9, v56, v57

    v_sub_f32 v54, v68, v50
    v_sub_f32 v55, v69, v50
    v_cvt_pk_bf16_f32 v56, v54, v55
    v_lshlrev_b32 v54, 16, v56
    v_and_b32 v55, 0xffff0000, v56
    v_mul_f32 v56, v54, v53
    v_mul_f32 v57, v55, v53
    v_fma_f32 v58, -v56, v52, v54
    v_fma_f32 v59, -v57, v52, v55
    v_fmac_f32 v56, v58, v53
    v_fmac_f32 v57, v59, v53
    v_cvt_pk_bf16_f32 v10, v56, v57

    v_sub_f32 v54, v70, v50
    v_sub_f32 v55, v71, v50
    v_cvt_pk_bf16_f32 v56, v54, v55
    v_lshlrev_b32 v54, 16, v56
    v_and_b32 v55, 0xffff0000, v56
    v_mul_f32 v56, v54, v53
    v_mul_f32 v57, v55, v53
    v_fma_f32 v58, -v56, v52, v54
    v_fma_f32 v59, -v57, v52, v55
    v_fmac_f32 v56, v58, v53
    v_fmac_f32 v57, v59, v53
    v_cvt_pk_bf16_f32 v11, v56, v57

    s_mov_b32 s17, 0
    buffer_store_dwordx4 v[8:11], v6, s[12:15], s17 offen
    v_sub_f32 v54, v72, v50
    v_sub_f32 v55, v73, v50
    v_cvt_pk_bf16_f32 v56, v54, v55
    v_lshlrev_b32 v54, 16, v56
    v_and_b32 v55, 0xffff0000, v56
    v_mul_f32 v56, v54, v53
    v_mul_f32 v57, v55, v53
    v_fma_f32 v58, -v56, v52, v54
    v_fma_f32 v59, -v57, v52, v55
    v_fmac_f32 v56, v58, v53
    v_fmac_f32 v57, v59, v53
    v_cvt_pk_bf16_f32 v12, v56, v57

    v_sub_f32 v54, v74, v50
    v_sub_f32 v55, v75, v50
    v_cvt_pk_bf16_f32 v56, v54, v55
    v_lshlrev_b32 v54, 16, v56
    v_and_b32 v55, 0xffff0000, v56
    v_mul_f32 v56, v54, v53
    v_mul_f32 v57, v55, v53
    v_fma_f32 v58, -v56, v52, v54
    v_fma_f32 v59, -v57, v52, v55
    v_fmac_f32 v56, v58, v53
    v_fmac_f32 v57, v59, v53
    v_cvt_pk_bf16_f32 v13, v56, v57

    v_sub_f32 v54, v76, v50
    v_sub_f32 v55, v77, v50
    v_cvt_pk_bf16_f32 v56, v54, v55
    v_lshlrev_b32 v54, 16, v56
    v_and_b32 v55, 0xffff0000, v56
    v_mul_f32 v56, v54, v53
    v_mul_f32 v57, v55, v53
    v_fma_f32 v58, -v56, v52, v54
    v_fma_f32 v59, -v57, v52, v55
    v_fmac_f32 v56, v58, v53
    v_fmac_f32 v57, v59, v53
    v_cvt_pk_bf16_f32 v14, v56, v57

    v_sub_f32 v54, v78, v50
    v_sub_f32 v55, v79, v50
    v_cvt_pk_bf16_f32 v56, v54, v55
    v_lshlrev_b32 v54, 16, v56
    v_and_b32 v55, 0xffff0000, v56
    v_mul_f32 v56, v54, v53
    v_mul_f32 v57, v55, v53
    v_fma_f32 v58, -v56, v52, v54
    v_fma_f32 v59, -v57, v52, v55
    v_fmac_f32 v56, v58, v53
    v_fmac_f32 v57, v59, v53
    v_cvt_pk_bf16_f32 v15, v56, v57

    s_mov_b32 s17, 262144
    buffer_store_dwordx4 v[12:15], v6, s[12:15], s17 offen
    v_sub_f32 v54, v80, v50
    v_sub_f32 v55, v81, v50
    v_cvt_pk_bf16_f32 v56, v54, v55
    v_lshlrev_b32 v54, 16, v56
    v_and_b32 v55, 0xffff0000, v56
    v_mul_f32 v56, v54, v53
    v_mul_f32 v57, v55, v53
    v_fma_f32 v58, -v56, v52, v54
    v_fma_f32 v59, -v57, v52, v55
    v_fmac_f32 v56, v58, v53
    v_fmac_f32 v57, v59, v53
    v_cvt_pk_bf16_f32 v16, v56, v57

    v_sub_f32 v54, v82, v50
    v_sub_f32 v55, v83, v50
    v_cvt_pk_bf16_f32 v56, v54, v55
    v_lshlrev_b32 v54, 16, v56
    v_and_b32 v55, 0xffff0000, v56
    v_mul_f32 v56, v54, v53
    v_mul_f32 v57, v55, v53
    v_fma_f32 v58, -v56, v52, v54
    v_fma_f32 v59, -v57, v52, v55
    v_fmac_f32 v56, v58, v53
    v_fmac_f32 v57, v59, v53
    v_cvt_pk_bf16_f32 v17, v56, v57

    v_sub_f32 v54, v84, v50
    v_sub_f32 v55, v85, v50
    v_cvt_pk_bf16_f32 v56, v54, v55
    v_lshlrev_b32 v54, 16, v56
    v_and_b32 v55, 0xffff0000, v56
    v_mul_f32 v56, v54, v53
    v_mul_f32 v57, v55, v53
    v_fma_f32 v58, -v56, v52, v54
    v_fma_f32 v59, -v57, v52, v55
    v_fmac_f32 v56, v58, v53
    v_fmac_f32 v57, v59, v53
    v_cvt_pk_bf16_f32 v18, v56, v57

    v_sub_f32 v54, v86, v50
    v_sub_f32 v55, v87, v50
    v_cvt_pk_bf16_f32 v56, v54, v55
    v_lshlrev_b32 v54, 16, v56
    v_and_b32 v55, 0xffff0000, v56
    v_mul_f32 v56, v54, v53
    v_mul_f32 v57, v55, v53
    v_fma_f32 v58, -v56, v52, v54
    v_fma_f32 v59, -v57, v52, v55
    v_fmac_f32 v56, v58, v53
    v_fmac_f32 v57, v59, v53
    v_cvt_pk_bf16_f32 v19, v56, v57

    s_mov_b32 s17, 524288
    buffer_store_dwordx4 v[16:19], v6, s[12:15], s17 offen
    v_sub_f32 v54, v88, v50
    v_sub_f32 v55, v89, v50
    v_cvt_pk_bf16_f32 v56, v54, v55
    v_lshlrev_b32 v54, 16, v56
    v_and_b32 v55, 0xffff0000, v56
    v_mul_f32 v56, v54, v53
    v_mul_f32 v57, v55, v53
    v_fma_f32 v58, -v56, v52, v54
    v_fma_f32 v59, -v57, v52, v55
    v_fmac_f32 v56, v58, v53
    v_fmac_f32 v57, v59, v53
    v_cvt_pk_bf16_f32 v20, v56, v57

    v_sub_f32 v54, v90, v50
    v_sub_f32 v55, v91, v50
    v_cvt_pk_bf16_f32 v56, v54, v55
    v_lshlrev_b32 v54, 16, v56
    v_and_b32 v55, 0xffff0000, v56
    v_mul_f32 v56, v54, v53
    v_mul_f32 v57, v55, v53
    v_fma_f32 v58, -v56, v52, v54
    v_fma_f32 v59, -v57, v52, v55
    v_fmac_f32 v56, v58, v53
    v_fmac_f32 v57, v59, v53
    v_cvt_pk_bf16_f32 v21, v56, v57

    v_sub_f32 v54, v92, v50
    v_sub_f32 v55, v93, v50
    v_cvt_pk_bf16_f32 v56, v54, v55
    v_lshlrev_b32 v54, 16, v56
    v_and_b32 v55, 0xffff0000, v56
    v_mul_f32 v56, v54, v53
    v_mul_f32 v57, v55, v53
    v_fma_f32 v58, -v56, v52, v54
    v_fma_f32 v59, -v57, v52, v55
    v_fmac_f32 v56, v58, v53
    v_fmac_f32 v57, v59, v53
    v_cvt_pk_bf16_f32 v22, v56, v57

    v_sub_f32 v54, v94, v50
    v_sub_f32 v55, v95, v50
    v_cvt_pk_bf16_f32 v56, v54, v55
    v_lshlrev_b32 v54, 16, v56
    v_and_b32 v55, 0xffff0000, v56
    v_mul_f32 v56, v54, v53
    v_mul_f32 v57, v55, v53
    v_fma_f32 v58, -v56, v52, v54
    v_fma_f32 v59, -v57, v52, v55
    v_fmac_f32 v56, v58, v53
    v_fmac_f32 v57, v59, v53
    v_cvt_pk_bf16_f32 v23, v56, v57

    s_mov_b32 s17, 786432
    buffer_store_dwordx4 v[20:23], v6, s[12:15], s17 offen
    v_sub_f32 v54, v96, v50
    v_sub_f32 v55, v97, v50
    v_cvt_pk_bf16_f32 v56, v54, v55
    v_lshlrev_b32 v54, 16, v56
    v_and_b32 v55, 0xffff0000, v56
    v_mul_f32 v56, v54, v53
    v_mul_f32 v57, v55, v53
    v_fma_f32 v58, -v56, v52, v54
    v_fma_f32 v59, -v57, v52, v55
    v_fmac_f32 v56, v58, v53
    v_fmac_f32 v57, v59, v53
    v_cvt_pk_bf16_f32 v24, v56, v57

    v_sub_f32 v54, v98, v50
    v_sub_f32 v55, v99, v50
    v_cvt_pk_bf16_f32 v56, v54, v55
    v_lshlrev_b32 v54, 16, v56
    v_and_b32 v55, 0xffff0000, v56
    v_mul_f32 v56, v54, v53
    v_mul_f32 v57, v55, v53
    v_fma_f32 v58, -v56, v52, v54
    v_fma_f32 v59, -v57, v52, v55
    v_fmac_f32 v56, v58, v53
    v_fmac_f32 v57, v59, v53
    v_cvt_pk_bf16_f32 v25, v56, v57

    v_sub_f32 v54, v100, v50
    v_sub_f32 v55, v101, v50
    v_cvt_pk_bf16_f32 v56, v54, v55
    v_lshlrev_b32 v54, 16, v56
    v_and_b32 v55, 0xffff0000, v56
    v_mul_f32 v56, v54, v53
    v_mul_f32 v57, v55, v53
    v_fma_f32 v58, -v56, v52, v54
    v_fma_f32 v59, -v57, v52, v55
    v_fmac_f32 v56, v58, v53
    v_fmac_f32 v57, v59, v53
    v_cvt_pk_bf16_f32 v26, v56, v57

    v_sub_f32 v54, v102, v50
    v_sub_f32 v55, v103, v50
    v_cvt_pk_bf16_f32 v56, v54, v55
    v_lshlrev_b32 v54, 16, v56
    v_and_b32 v55, 0xffff0000, v56
    v_mul_f32 v56, v54, v53
    v_mul_f32 v57, v55, v53
    v_fma_f32 v58, -v56, v52, v54
    v_fma_f32 v59, -v57, v52, v55
    v_fmac_f32 v56, v58, v53
    v_fmac_f32 v57, v59, v53
    v_cvt_pk_bf16_f32 v27, v56, v57

    s_mov_b32 s17, 1048576
    buffer_store_dwordx4 v[24:27], v6, s[12:15], s17 offen
    v_sub_f32 v54, v104, v50
    v_sub_f32 v55, v105, v50
    v_cvt_pk_bf16_f32 v56, v54, v55
    v_lshlrev_b32 v54, 16, v56
    v_and_b32 v55, 0xffff0000, v56
    v_mul_f32 v56, v54, v53
    v_mul_f32 v57, v55, v53
    v_fma_f32 v58, -v56, v52, v54
    v_fma_f32 v59, -v57, v52, v55
    v_fmac_f32 v56, v58, v53
    v_fmac_f32 v57, v59, v53
    v_cvt_pk_bf16_f32 v28, v56, v57

    v_sub_f32 v54, v106, v50
    v_sub_f32 v55, v107, v50
    v_cvt_pk_bf16_f32 v56, v54, v55
    v_lshlrev_b32 v54, 16, v56
    v_and_b32 v55, 0xffff0000, v56
    v_mul_f32 v56, v54, v53
    v_mul_f32 v57, v55, v53
    v_fma_f32 v58, -v56, v52, v54
    v_fma_f32 v59, -v57, v52, v55
    v_fmac_f32 v56, v58, v53
    v_fmac_f32 v57, v59, v53
    v_cvt_pk_bf16_f32 v29, v56, v57

    v_sub_f32 v54, v108, v50
    v_sub_f32 v55, v109, v50
    v_cvt_pk_bf16_f32 v56, v54, v55
    v_lshlrev_b32 v54, 16, v56
    v_and_b32 v55, 0xffff0000, v56
    v_mul_f32 v56, v54, v53
    v_mul_f32 v57, v55, v53
    v_fma_f32 v58, -v56, v52, v54
    v_fma_f32 v59, -v57, v52, v55
    v_fmac_f32 v56, v58, v53
    v_fmac_f32 v57, v59, v53
    v_cvt_pk_bf16_f32 v30, v56, v57

    v_sub_f32 v54, v110, v50
    v_sub_f32 v55, v111, v50
    v_cvt_pk_bf16_f32 v56, v54, v55
    v_lshlrev_b32 v54, 16, v56
    v_and_b32 v55, 0xffff0000, v56
    v_mul_f32 v56, v54, v53
    v_mul_f32 v57, v55, v53
    v_fma_f32 v58, -v56, v52, v54
    v_fma_f32 v59, -v57, v52, v55
    v_fmac_f32 v56, v58, v53
    v_fmac_f32 v57, v59, v53
    v_cvt_pk_bf16_f32 v31, v56, v57

    s_mov_b32 s17, 1310720
    buffer_store_dwordx4 v[28:31], v6, s[12:15], s17 offen
    v_sub_f32 v54, v112, v50
    v_sub_f32 v55, v113, v50
    v_cvt_pk_bf16_f32 v56, v54, v55
    v_lshlrev_b32 v54, 16, v56
    v_and_b32 v55, 0xffff0000, v56
    v_mul_f32 v56, v54, v53
    v_mul_f32 v57, v55, v53
    v_fma_f32 v58, -v56, v52, v54
    v_fma_f32 v59, -v57, v52, v55
    v_fmac_f32 v56, v58, v53
    v_fmac_f32 v57, v59, v53
    v_cvt_pk_bf16_f32 v32, v56, v57

    v_sub_f32 v54, v114, v50
    v_sub_f32 v55, v115, v50
    v_cvt_pk_bf16_f32 v56, v54, v55
    v_lshlrev_b32 v54, 16, v56
    v_and_b32 v55, 0xffff0000, v56
    v_mul_f32 v56, v54, v53
    v_mul_f32 v57, v55, v53
    v_fma_f32 v58, -v56, v52, v54
    v_fma_f32 v59, -v57, v52, v55
    v_fmac_f32 v56, v58, v53
    v_fmac_f32 v57, v59, v53
    v_cvt_pk_bf16_f32 v33, v56, v57

    v_sub_f32 v54, v116, v50
    v_sub_f32 v55, v117, v50
    v_cvt_pk_bf16_f32 v56, v54, v55
    v_lshlrev_b32 v54, 16, v56
    v_and_b32 v55, 0xffff0000, v56
    v_mul_f32 v56, v54, v53
    v_mul_f32 v57, v55, v53
    v_fma_f32 v58, -v56, v52, v54
    v_fma_f32 v59, -v57, v52, v55
    v_fmac_f32 v56, v58, v53
    v_fmac_f32 v57, v59, v53
    v_cvt_pk_bf16_f32 v34, v56, v57

    v_sub_f32 v54, v118, v50
    v_sub_f32 v55, v119, v50
    v_cvt_pk_bf16_f32 v56, v54, v55
    v_lshlrev_b32 v54, 16, v56
    v_and_b32 v55, 0xffff0000, v56
    v_mul_f32 v56, v54, v53
    v_mul_f32 v57, v55, v53
    v_fma_f32 v58, -v56, v52, v54
    v_fma_f32 v59, -v57, v52, v55
    v_fmac_f32 v56, v58, v53
    v_fmac_f32 v57, v59, v53
    v_cvt_pk_bf16_f32 v35, v56, v57

    s_mov_b32 s17, 1572864
    buffer_store_dwordx4 v[32:35], v6, s[12:15], s17 offen
    v_sub_f32 v54, v120, v50
    v_sub_f32 v55, v121, v50
    v_cvt_pk_bf16_f32 v56, v54, v55
    v_lshlrev_b32 v54, 16, v56
    v_and_b32 v55, 0xffff0000, v56
    v_mul_f32 v56, v54, v53
    v_mul_f32 v57, v55, v53
    v_fma_f32 v58, -v56, v52, v54
    v_fma_f32 v59, -v57, v52, v55
    v_fmac_f32 v56, v58, v53
    v_fmac_f32 v57, v59, v53
    v_cvt_pk_bf16_f32 v36, v56, v57

    v_sub_f32 v54, v122, v50
    v_sub_f32 v55, v123, v50
    v_cvt_pk_bf16_f32 v56, v54, v55
    v_lshlrev_b32 v54, 16, v56
    v_and_b32 v55, 0xffff0000, v56
    v_mul_f32 v56, v54, v53
    v_mul_f32 v57, v55, v53
    v_fma_f32 v58, -v56, v52, v54
    v_fma_f32 v59, -v57, v52, v55
    v_fmac_f32 v56, v58, v53
    v_fmac_f32 v57, v59, v53
    v_cvt_pk_bf16_f32 v37, v56, v57

    v_sub_f32 v54, v124, v50
    v_sub_f32 v55, v125, v50
    v_cvt_pk_bf16_f32 v56, v54, v55
    v_lshlrev_b32 v54, 16, v56
    v_and_b32 v55, 0xffff0000, v56
    v_mul_f32 v56, v54, v53
    v_mul_f32 v57, v55, v53
    v_fma_f32 v58, -v56, v52, v54
    v_fma_f32 v59, -v57, v52, v55
    v_fmac_f32 v56, v58, v53
    v_fmac_f32 v57, v59, v53
    v_cvt_pk_bf16_f32 v38, v56, v57

    v_sub_f32 v54, v126, v50
    v_sub_f32 v55, v127, v50
    v_cvt_pk_bf16_f32 v56, v54, v55
    v_lshlrev_b32 v54, 16, v56
    v_and_b32 v55, 0xffff0000, v56
    v_mul_f32 v56, v54, v53
    v_mul_f32 v57, v55, v53
    v_fma_f32 v58, -v56, v52, v54
    v_fma_f32 v59, -v57, v52, v55
    v_fmac_f32 v56, v58, v53
    v_fmac_f32 v57, v59, v53
    v_cvt_pk_bf16_f32 v39, v56, v57

    s_mov_b32 s17, 1835008
    buffer_store_dwordx4 v[36:39], v6, s[12:15], s17 offen
    v_sub_f32 v54, v128, v50
    v_sub_f32 v55, v129, v50
    v_cvt_pk_bf16_f32 v56, v54, v55
    v_lshlrev_b32 v54, 16, v56
    v_and_b32 v55, 0xffff0000, v56
    v_mul_f32 v56, v54, v53
    v_mul_f32 v57, v55, v53
    v_fma_f32 v58, -v56, v52, v54
    v_fma_f32 v59, -v57, v52, v55
    v_fmac_f32 v56, v58, v53
    v_fmac_f32 v57, v59, v53
    v_cvt_pk_bf16_f32 v40, v56, v57

    v_sub_f32 v54, v130, v50
    v_sub_f32 v55, v131, v50
    v_cvt_pk_bf16_f32 v56, v54, v55
    v_lshlrev_b32 v54, 16, v56
    v_and_b32 v55, 0xffff0000, v56
    v_mul_f32 v56, v54, v53
    v_mul_f32 v57, v55, v53
    v_fma_f32 v58, -v56, v52, v54
    v_fma_f32 v59, -v57, v52, v55
    v_fmac_f32 v56, v58, v53
    v_fmac_f32 v57, v59, v53
    v_cvt_pk_bf16_f32 v41, v56, v57

    v_sub_f32 v54, v132, v50
    v_sub_f32 v55, v133, v50
    v_cvt_pk_bf16_f32 v56, v54, v55
    v_lshlrev_b32 v54, 16, v56
    v_and_b32 v55, 0xffff0000, v56
    v_mul_f32 v56, v54, v53
    v_mul_f32 v57, v55, v53
    v_fma_f32 v58, -v56, v52, v54
    v_fma_f32 v59, -v57, v52, v55
    v_fmac_f32 v56, v58, v53
    v_fmac_f32 v57, v59, v53
    v_cvt_pk_bf16_f32 v42, v56, v57

    v_sub_f32 v54, v134, v50
    v_sub_f32 v55, v135, v50
    v_cvt_pk_bf16_f32 v56, v54, v55
    v_lshlrev_b32 v54, 16, v56
    v_and_b32 v55, 0xffff0000, v56
    v_mul_f32 v56, v54, v53
    v_mul_f32 v57, v55, v53
    v_fma_f32 v58, -v56, v52, v54
    v_fma_f32 v59, -v57, v52, v55
    v_fmac_f32 v56, v58, v53
    v_fmac_f32 v57, v59, v53
    v_cvt_pk_bf16_f32 v43, v56, v57

    s_mov_b32 s17, 2097152
    buffer_store_dwordx4 v[40:43], v6, s[12:15], s17 offen
LN_END:
    s_endpgm
RP_ROLE:
    s_cmp_ge_u32 s2, 976
    s_cbranch_scc1 LN_END
    s_load_dwordx2 s[4:5], s[0:1], 72
    s_load_dwordx2 s[6:7], s[0:1], 48
    s_load_dwordx2 s[8:9], s[0:1], 16
    s_load_dwordx2 s[10:11], s[0:1], 8
    s_cmp_ge_u32 s2, 904
    s_cbranch_scc1 RPQ_ROLE
    s_sub_u32 s20, s2, 256
    s_lshr_b32 s21, s20, 2
    s_and_b32 s22, s20, 3
    s_lshl_b32 s22, s22, 1
    s_waitcnt lgkmcnt(0)
    s_sub_u32 s23, s21, 144
    s_cmp_ge_u32 s21, 144
    s_cselect_b32 s12, s8, s6
    s_cselect_b32 s13, s9, s7
    s_mov_b32 s14, 5308416
    s_mov_b32 s15, 0x00020000
    s_cselect_b32 s23, s23, s21
    s_mul_i32 s23, s23, 36864
    s_mul_i32 s24, s22, 144
    s_add_u32 s23, s23, s24
    s_mul_i32 s25, s21, 4608

    s_add_u32 s16, s4, 0x2000000
    s_addc_u32 s17, s5, 0
    s_mov_b32 s18, 0x5b2000
    s_mov_b32 s19, 0x00020000
    s_mul_i32 s24, s22, 746496
    s_add_u32 s25, s25, s24
    v_lshrrev_b32 v1, 1, v0
    v_mul_u32_u24 v1, 1152, v1
    v_and_b32 v2, 1, v0
    v_lshl_add_u32 v1, v2, 4, v1
    v_mul_u32_u24 v2, 1152, v0
    v_add_u32 v2, 128, v2
    v_lshlrev_b32 v3, 4, v0
    v_add_u32 v4, 4096, v3
    v_mov_b32 v5, 0x7f000000
    v_cmp_gt_u32 vcc, 32, v0
    s_nop 1
    v_cndmask_b32 v2, v5, v2, vcc
    v_cndmask_b32 v4, v5, v4, vcc
    s_add_u32 s26, s23, 144
    s_add_u32 s27, s25, 746496

    buffer_load_dwordx4 v[8:11], v1, s[12:15], s23 offen offset:0
    buffer_load_dwordx4 v[12:15], v1, s[12:15], s23 offen offset:32
    buffer_load_dwordx4 v[16:19], v1, s[12:15], s23 offen offset:64
    buffer_load_dwordx4 v[20:23], v1, s[12:15], s23 offen offset:96
    buffer_load_dwordx4 v[24:27], v2, s[12:15], s23 offen
    buffer_load_dwordx4 v[28:31], v1, s[12:15], s26 offen offset:0
    buffer_load_dwordx4 v[32:35], v1, s[12:15], s26 offen offset:32
    buffer_load_dwordx4 v[36:39], v1, s[12:15], s26 offen offset:64
    buffer_load_dwordx4 v[40:43], v1, s[12:15], s26 offen offset:96
    buffer_load_dwordx4 v[44:47], v2, s[12:15], s26 offen
    s_waitcnt vmcnt(9)
    buffer_store_dwordx4 v[8:11], v3, s[16:19], s25 offen offset:0
    s_waitcnt vmcnt(9)
    buffer_store_dwordx4 v[12:15], v3, s[16:19], s25 offen offset:1024
    s_waitcnt vmcnt(9)
    buffer_store_dwordx4 v[16:19], v3, s[16:19], s25 offen offset:2048
    s_waitcnt vmcnt(9)
    buffer_store_dwordx4 v[20:23], v3, s[16:19], s25 offen offset:3072
    s_waitcnt vmcnt(9)
    buffer_store_dwordx4 v[24:27], v4, s[16:19], s25 offen
    s_waitcnt vmcnt(9)
    buffer_store_dwordx4 v[28:31], v3, s[16:19], s27 offen offset:0
    s_waitcnt vmcnt(9)
    buffer_store_dwordx4 v[32:35], v3, s[16:19], s27 offen offset:1024
    s_waitcnt vmcnt(9)
    buffer_store_dwordx4 v[36:39], v3, s[16:19], s27 offen offset:2048
    s_waitcnt vmcnt(9)
    buffer_store_dwordx4 v[40:43], v3, s[16:19], s27 offen offset:3072
    s_waitcnt vmcnt(9)
    buffer_store_dwordx4 v[44:47], v4, s[16:19], s27 offen
    s_endpgm
RPQ_ROLE:
    s_sub_u32 s20, s2, 904
    s_lshl_b32 s20, s20, 3
    s_waitcnt lgkmcnt(0)

    s_mov_b32 s12, s10
    s_mov_b32 s13, s11
    s_mov_b32 s14, 0x1e6000
    s_mov_b32 s15, 0x00020000
    s_add_u32 s16, s4, 0x3000000
    s_addc_u32 s17, s5, 0
    s_mov_b32 s18, 0x1e6000
    s_mov_b32 s19, 0x00020000
    s_mul_i32 s21, s20, 3456
    s_mul_i32 s22, s20, 864
    v_lshlrev_b32 v1, 4, v0

    buffer_load_dwordx4 v[8:11], v1, s[12:15], s21 offen offset:0
    buffer_load_dwordx4 v[12:15], v1, s[12:15], s21 offen offset:1024
    buffer_load_dwordx4 v[16:19], v1, s[12:15], s21 offen offset:2048
    buffer_load_dwordx4 v[20:23], v1, s[12:15], s21 offen offset:3072
    s_add_u32 s21, s21, 4096
    buffer_load_dwordx4 v[24:27], v1, s[12:15], s21 offen offset:0
    buffer_load_dwordx4 v[28:31], v1, s[12:15], s21 offen offset:1024
    buffer_load_dwordx4 v[32:35], v1, s[12:15], s21 offen offset:2048
    buffer_load_dwordx4 v[36:39], v1, s[12:15], s21 offen offset:3072
    s_add_u32 s21, s21, 4096
    buffer_load_dwordx4 v[40:43], v1, s[12:15], s21 offen offset:0
    buffer_load_dwordx4 v[44:47], v1, s[12:15], s21 offen offset:1024
    buffer_load_dwordx4 v[48:51], v1, s[12:15], s21 offen offset:2048
    buffer_load_dwordx4 v[52:55], v1, s[12:15], s21 offen offset:3072
    s_add_u32 s21, s21, 4096
    buffer_load_dwordx4 v[56:59], v1, s[12:15], s21 offen offset:0
    buffer_load_dwordx4 v[60:63], v1, s[12:15], s21 offen offset:1024
    buffer_load_dwordx4 v[64:67], v1, s[12:15], s21 offen offset:2048
    buffer_load_dwordx4 v[68:71], v1, s[12:15], s21 offen offset:3072
    s_add_u32 s21, s21, 4096
    buffer_load_dwordx4 v[72:75], v1, s[12:15], s21 offen offset:0
    buffer_load_dwordx4 v[76:79], v1, s[12:15], s21 offen offset:1024
    buffer_load_dwordx4 v[80:83], v1, s[12:15], s21 offen offset:2048
    buffer_load_dwordx4 v[84:87], v1, s[12:15], s21 offen offset:3072
    s_add_u32 s21, s21, 4096
    buffer_load_dwordx4 v[88:91], v1, s[12:15], s21 offen offset:0
    buffer_load_dwordx4 v[92:95], v1, s[12:15], s21 offen offset:1024
    buffer_load_dwordx4 v[96:99], v1, s[12:15], s21 offen offset:2048
    buffer_load_dwordx4 v[100:103], v1, s[12:15], s21 offen offset:3072
    s_add_u32 s21, s21, 4096
    buffer_load_dwordx4 v[104:107], v1, s[12:15], s21 offen offset:0
    buffer_load_dwordx4 v[108:111], v1, s[12:15], s21 offen offset:1024
    buffer_load_dwordx4 v[112:115], v1, s[12:15], s21 offen offset:2048
    v_add_u32 v2, 0, v0
    v_mul_u32_u24 v3, 1214, v2
    v_lshrrev_b32 v3, 18, v3
    v_mul_u32_u24 v4, 216, v3
    v_sub_u32 v4, v2, v4
    v_mul_u32_u24 v5, 911, v4
    v_lshrrev_b32 v5, 16, v5
    v_mul_u32_u24 v6, 72, v5
    v_sub_u32 v6, v4, v6
    v_mul_u32_u24 v7, 3641, v6
    v_lshrrev_b32 v7, 16, v7
    v_mul_u32_u24 v120, 18, v7
    v_sub_u32 v6, v6, v120
    v_mul_u32_u24 v5, 18, v5
    v_add_u32 v6, v6, v5
    v_mul_u32_u24 v3, 864, v3
    v_lshl_add_u32 v3, v6, 4, v3
    s_mov_b32 s24, 497664
    v_mul_lo_u32 v7, v7, s24
    v_add_u32 v3, v3, v7
    s_waitcnt vmcnt(26)
    buffer_store_dwordx4 v[8:11], v3, s[16:19], s22 offen

    v_add_u32 v2, 64, v0
    v_mul_u32_u24 v3, 1214, v2
    v_lshrrev_b32 v3, 18, v3
    v_mul_u32_u24 v4, 216, v3
    v_sub_u32 v4, v2, v4
    v_mul_u32_u24 v5, 911, v4
    v_lshrrev_b32 v5, 16, v5
    v_mul_u32_u24 v6, 72, v5
    v_sub_u32 v6, v4, v6
    v_mul_u32_u24 v7, 3641, v6
    v_lshrrev_b32 v7, 16, v7
    v_mul_u32_u24 v120, 18, v7
    v_sub_u32 v6, v6, v120
    v_mul_u32_u24 v5, 18, v5
    v_add_u32 v6, v6, v5
    v_mul_u32_u24 v3, 864, v3
    v_lshl_add_u32 v3, v6, 4, v3
    s_mov_b32 s24, 497664
    v_mul_lo_u32 v7, v7, s24
    v_add_u32 v3, v3, v7
    s_waitcnt vmcnt(26)
    buffer_store_dwordx4 v[12:15], v3, s[16:19], s22 offen

    v_add_u32 v2, 128, v0
    v_mul_u32_u24 v3, 1214, v2
    v_lshrrev_b32 v3, 18, v3
    v_mul_u32_u24 v4, 216, v3
    v_sub_u32 v4, v2, v4
    v_mul_u32_u24 v5, 911, v4
    v_lshrrev_b32 v5, 16, v5
    v_mul_u32_u24 v6, 72, v5
    v_sub_u32 v6, v4, v6
    v_mul_u32_u24 v7, 3641, v6
    v_lshrrev_b32 v7, 16, v7
    v_mul_u32_u24 v120, 18, v7
    v_sub_u32 v6, v6, v120
    v_mul_u32_u24 v5, 18, v5
    v_add_u32 v6, v6, v5
    v_mul_u32_u24 v3, 864, v3
    v_lshl_add_u32 v3, v6, 4, v3
    s_mov_b32 s24, 497664
    v_mul_lo_u32 v7, v7, s24
    v_add_u32 v3, v3, v7
    s_waitcnt vmcnt(26)
    buffer_store_dwordx4 v[16:19], v3, s[16:19], s22 offen

    v_add_u32 v2, 192, v0
    v_mul_u32_u24 v3, 1214, v2
    v_lshrrev_b32 v3, 18, v3
    v_mul_u32_u24 v4, 216, v3
    v_sub_u32 v4, v2, v4
    v_mul_u32_u24 v5, 911, v4
    v_lshrrev_b32 v5, 16, v5
    v_mul_u32_u24 v6, 72, v5
    v_sub_u32 v6, v4, v6
    v_mul_u32_u24 v7, 3641, v6
    v_lshrrev_b32 v7, 16, v7
    v_mul_u32_u24 v120, 18, v7
    v_sub_u32 v6, v6, v120
    v_mul_u32_u24 v5, 18, v5
    v_add_u32 v6, v6, v5
    v_mul_u32_u24 v3, 864, v3
    v_lshl_add_u32 v3, v6, 4, v3
    s_mov_b32 s24, 497664
    v_mul_lo_u32 v7, v7, s24
    v_add_u32 v3, v3, v7
    s_waitcnt vmcnt(26)
    buffer_store_dwordx4 v[20:23], v3, s[16:19], s22 offen

    v_add_u32 v2, 256, v0
    v_mul_u32_u24 v3, 1214, v2
    v_lshrrev_b32 v3, 18, v3
    v_mul_u32_u24 v4, 216, v3
    v_sub_u32 v4, v2, v4
    v_mul_u32_u24 v5, 911, v4
    v_lshrrev_b32 v5, 16, v5
    v_mul_u32_u24 v6, 72, v5
    v_sub_u32 v6, v4, v6
    v_mul_u32_u24 v7, 3641, v6
    v_lshrrev_b32 v7, 16, v7
    v_mul_u32_u24 v120, 18, v7
    v_sub_u32 v6, v6, v120
    v_mul_u32_u24 v5, 18, v5
    v_add_u32 v6, v6, v5
    v_mul_u32_u24 v3, 864, v3
    v_lshl_add_u32 v3, v6, 4, v3
    s_mov_b32 s24, 497664
    v_mul_lo_u32 v7, v7, s24
    v_add_u32 v3, v3, v7
    s_waitcnt vmcnt(26)
    buffer_store_dwordx4 v[24:27], v3, s[16:19], s22 offen

    v_add_u32 v2, 320, v0
    v_mul_u32_u24 v3, 1214, v2
    v_lshrrev_b32 v3, 18, v3
    v_mul_u32_u24 v4, 216, v3
    v_sub_u32 v4, v2, v4
    v_mul_u32_u24 v5, 911, v4
    v_lshrrev_b32 v5, 16, v5
    v_mul_u32_u24 v6, 72, v5
    v_sub_u32 v6, v4, v6
    v_mul_u32_u24 v7, 3641, v6
    v_lshrrev_b32 v7, 16, v7
    v_mul_u32_u24 v120, 18, v7
    v_sub_u32 v6, v6, v120
    v_mul_u32_u24 v5, 18, v5
    v_add_u32 v6, v6, v5
    v_mul_u32_u24 v3, 864, v3
    v_lshl_add_u32 v3, v6, 4, v3
    s_mov_b32 s24, 497664
    v_mul_lo_u32 v7, v7, s24
    v_add_u32 v3, v3, v7
    s_waitcnt vmcnt(26)
    buffer_store_dwordx4 v[28:31], v3, s[16:19], s22 offen

    v_add_u32 v2, 384, v0
    v_mul_u32_u24 v3, 1214, v2
    v_lshrrev_b32 v3, 18, v3
    v_mul_u32_u24 v4, 216, v3
    v_sub_u32 v4, v2, v4
    v_mul_u32_u24 v5, 911, v4
    v_lshrrev_b32 v5, 16, v5
    v_mul_u32_u24 v6, 72, v5
    v_sub_u32 v6, v4, v6
    v_mul_u32_u24 v7, 3641, v6
    v_lshrrev_b32 v7, 16, v7
    v_mul_u32_u24 v120, 18, v7
    v_sub_u32 v6, v6, v120
    v_mul_u32_u24 v5, 18, v5
    v_add_u32 v6, v6, v5
    v_mul_u32_u24 v3, 864, v3
    v_lshl_add_u32 v3, v6, 4, v3
    s_mov_b32 s24, 497664
    v_mul_lo_u32 v7, v7, s24
    v_add_u32 v3, v3, v7
    s_waitcnt vmcnt(26)
    buffer_store_dwordx4 v[32:35], v3, s[16:19], s22 offen

    v_add_u32 v2, 448, v0
    v_mul_u32_u24 v3, 1214, v2
    v_lshrrev_b32 v3, 18, v3
    v_mul_u32_u24 v4, 216, v3
    v_sub_u32 v4, v2, v4
    v_mul_u32_u24 v5, 911, v4
    v_lshrrev_b32 v5, 16, v5
    v_mul_u32_u24 v6, 72, v5
    v_sub_u32 v6, v4, v6
    v_mul_u32_u24 v7, 3641, v6
    v_lshrrev_b32 v7, 16, v7
    v_mul_u32_u24 v120, 18, v7
    v_sub_u32 v6, v6, v120
    v_mul_u32_u24 v5, 18, v5
    v_add_u32 v6, v6, v5
    v_mul_u32_u24 v3, 864, v3
    v_lshl_add_u32 v3, v6, 4, v3
    s_mov_b32 s24, 497664
    v_mul_lo_u32 v7, v7, s24
    v_add_u32 v3, v3, v7
    s_waitcnt vmcnt(26)
    buffer_store_dwordx4 v[36:39], v3, s[16:19], s22 offen

    v_add_u32 v2, 512, v0
    v_mul_u32_u24 v3, 1214, v2
    v_lshrrev_b32 v3, 18, v3
    v_mul_u32_u24 v4, 216, v3
    v_sub_u32 v4, v2, v4
    v_mul_u32_u24 v5, 911, v4
    v_lshrrev_b32 v5, 16, v5
    v_mul_u32_u24 v6, 72, v5
    v_sub_u32 v6, v4, v6
    v_mul_u32_u24 v7, 3641, v6
    v_lshrrev_b32 v7, 16, v7
    v_mul_u32_u24 v120, 18, v7
    v_sub_u32 v6, v6, v120
    v_mul_u32_u24 v5, 18, v5
    v_add_u32 v6, v6, v5
    v_mul_u32_u24 v3, 864, v3
    v_lshl_add_u32 v3, v6, 4, v3
    s_mov_b32 s24, 497664
    v_mul_lo_u32 v7, v7, s24
    v_add_u32 v3, v3, v7
    s_waitcnt vmcnt(26)
    buffer_store_dwordx4 v[40:43], v3, s[16:19], s22 offen

    v_add_u32 v2, 576, v0
    v_mul_u32_u24 v3, 1214, v2
    v_lshrrev_b32 v3, 18, v3
    v_mul_u32_u24 v4, 216, v3
    v_sub_u32 v4, v2, v4
    v_mul_u32_u24 v5, 911, v4
    v_lshrrev_b32 v5, 16, v5
    v_mul_u32_u24 v6, 72, v5
    v_sub_u32 v6, v4, v6
    v_mul_u32_u24 v7, 3641, v6
    v_lshrrev_b32 v7, 16, v7
    v_mul_u32_u24 v120, 18, v7
    v_sub_u32 v6, v6, v120
    v_mul_u32_u24 v5, 18, v5
    v_add_u32 v6, v6, v5
    v_mul_u32_u24 v3, 864, v3
    v_lshl_add_u32 v3, v6, 4, v3
    s_mov_b32 s24, 497664
    v_mul_lo_u32 v7, v7, s24
    v_add_u32 v3, v3, v7
    s_waitcnt vmcnt(26)
    buffer_store_dwordx4 v[44:47], v3, s[16:19], s22 offen

    v_add_u32 v2, 640, v0
    v_mul_u32_u24 v3, 1214, v2
    v_lshrrev_b32 v3, 18, v3
    v_mul_u32_u24 v4, 216, v3
    v_sub_u32 v4, v2, v4
    v_mul_u32_u24 v5, 911, v4
    v_lshrrev_b32 v5, 16, v5
    v_mul_u32_u24 v6, 72, v5
    v_sub_u32 v6, v4, v6
    v_mul_u32_u24 v7, 3641, v6
    v_lshrrev_b32 v7, 16, v7
    v_mul_u32_u24 v120, 18, v7
    v_sub_u32 v6, v6, v120
    v_mul_u32_u24 v5, 18, v5
    v_add_u32 v6, v6, v5
    v_mul_u32_u24 v3, 864, v3
    v_lshl_add_u32 v3, v6, 4, v3
    s_mov_b32 s24, 497664
    v_mul_lo_u32 v7, v7, s24
    v_add_u32 v3, v3, v7
    s_waitcnt vmcnt(26)
    buffer_store_dwordx4 v[48:51], v3, s[16:19], s22 offen

    v_add_u32 v2, 704, v0
    v_mul_u32_u24 v3, 1214, v2
    v_lshrrev_b32 v3, 18, v3
    v_mul_u32_u24 v4, 216, v3
    v_sub_u32 v4, v2, v4
    v_mul_u32_u24 v5, 911, v4
    v_lshrrev_b32 v5, 16, v5
    v_mul_u32_u24 v6, 72, v5
    v_sub_u32 v6, v4, v6
    v_mul_u32_u24 v7, 3641, v6
    v_lshrrev_b32 v7, 16, v7
    v_mul_u32_u24 v120, 18, v7
    v_sub_u32 v6, v6, v120
    v_mul_u32_u24 v5, 18, v5
    v_add_u32 v6, v6, v5
    v_mul_u32_u24 v3, 864, v3
    v_lshl_add_u32 v3, v6, 4, v3
    s_mov_b32 s24, 497664
    v_mul_lo_u32 v7, v7, s24
    v_add_u32 v3, v3, v7
    s_waitcnt vmcnt(26)
    buffer_store_dwordx4 v[52:55], v3, s[16:19], s22 offen

    v_add_u32 v2, 768, v0
    v_mul_u32_u24 v3, 1214, v2
    v_lshrrev_b32 v3, 18, v3
    v_mul_u32_u24 v4, 216, v3
    v_sub_u32 v4, v2, v4
    v_mul_u32_u24 v5, 911, v4
    v_lshrrev_b32 v5, 16, v5
    v_mul_u32_u24 v6, 72, v5
    v_sub_u32 v6, v4, v6
    v_mul_u32_u24 v7, 3641, v6
    v_lshrrev_b32 v7, 16, v7
    v_mul_u32_u24 v120, 18, v7
    v_sub_u32 v6, v6, v120
    v_mul_u32_u24 v5, 18, v5
    v_add_u32 v6, v6, v5
    v_mul_u32_u24 v3, 864, v3
    v_lshl_add_u32 v3, v6, 4, v3
    s_mov_b32 s24, 497664
    v_mul_lo_u32 v7, v7, s24
    v_add_u32 v3, v3, v7
    s_waitcnt vmcnt(26)
    buffer_store_dwordx4 v[56:59], v3, s[16:19], s22 offen

    v_add_u32 v2, 832, v0
    v_mul_u32_u24 v3, 1214, v2
    v_lshrrev_b32 v3, 18, v3
    v_mul_u32_u24 v4, 216, v3
    v_sub_u32 v4, v2, v4
    v_mul_u32_u24 v5, 911, v4
    v_lshrrev_b32 v5, 16, v5
    v_mul_u32_u24 v6, 72, v5
    v_sub_u32 v6, v4, v6
    v_mul_u32_u24 v7, 3641, v6
    v_lshrrev_b32 v7, 16, v7
    v_mul_u32_u24 v120, 18, v7
    v_sub_u32 v6, v6, v120
    v_mul_u32_u24 v5, 18, v5
    v_add_u32 v6, v6, v5
    v_mul_u32_u24 v3, 864, v3
    v_lshl_add_u32 v3, v6, 4, v3
    s_mov_b32 s24, 497664
    v_mul_lo_u32 v7, v7, s24
    v_add_u32 v3, v3, v7
    s_waitcnt vmcnt(26)
    buffer_store_dwordx4 v[60:63], v3, s[16:19], s22 offen

    v_add_u32 v2, 896, v0
    v_mul_u32_u24 v3, 1214, v2
    v_lshrrev_b32 v3, 18, v3
    v_mul_u32_u24 v4, 216, v3
    v_sub_u32 v4, v2, v4
    v_mul_u32_u24 v5, 911, v4
    v_lshrrev_b32 v5, 16, v5
    v_mul_u32_u24 v6, 72, v5
    v_sub_u32 v6, v4, v6
    v_mul_u32_u24 v7, 3641, v6
    v_lshrrev_b32 v7, 16, v7
    v_mul_u32_u24 v120, 18, v7
    v_sub_u32 v6, v6, v120
    v_mul_u32_u24 v5, 18, v5
    v_add_u32 v6, v6, v5
    v_mul_u32_u24 v3, 864, v3
    v_lshl_add_u32 v3, v6, 4, v3
    s_mov_b32 s24, 497664
    v_mul_lo_u32 v7, v7, s24
    v_add_u32 v3, v3, v7
    s_waitcnt vmcnt(26)
    buffer_store_dwordx4 v[64:67], v3, s[16:19], s22 offen

    v_add_u32 v2, 960, v0
    v_mul_u32_u24 v3, 1214, v2
    v_lshrrev_b32 v3, 18, v3
    v_mul_u32_u24 v4, 216, v3
    v_sub_u32 v4, v2, v4
    v_mul_u32_u24 v5, 911, v4
    v_lshrrev_b32 v5, 16, v5
    v_mul_u32_u24 v6, 72, v5
    v_sub_u32 v6, v4, v6
    v_mul_u32_u24 v7, 3641, v6
    v_lshrrev_b32 v7, 16, v7
    v_mul_u32_u24 v120, 18, v7
    v_sub_u32 v6, v6, v120
    v_mul_u32_u24 v5, 18, v5
    v_add_u32 v6, v6, v5
    v_mul_u32_u24 v3, 864, v3
    v_lshl_add_u32 v3, v6, 4, v3
    s_mov_b32 s24, 497664
    v_mul_lo_u32 v7, v7, s24
    v_add_u32 v3, v3, v7
    s_waitcnt vmcnt(26)
    buffer_store_dwordx4 v[68:71], v3, s[16:19], s22 offen

    v_add_u32 v2, 1024, v0
    v_mul_u32_u24 v3, 1214, v2
    v_lshrrev_b32 v3, 18, v3
    v_mul_u32_u24 v4, 216, v3
    v_sub_u32 v4, v2, v4
    v_mul_u32_u24 v5, 911, v4
    v_lshrrev_b32 v5, 16, v5
    v_mul_u32_u24 v6, 72, v5
    v_sub_u32 v6, v4, v6
    v_mul_u32_u24 v7, 3641, v6
    v_lshrrev_b32 v7, 16, v7
    v_mul_u32_u24 v120, 18, v7
    v_sub_u32 v6, v6, v120
    v_mul_u32_u24 v5, 18, v5
    v_add_u32 v6, v6, v5
    v_mul_u32_u24 v3, 864, v3
    v_lshl_add_u32 v3, v6, 4, v3
    s_mov_b32 s24, 497664
    v_mul_lo_u32 v7, v7, s24
    v_add_u32 v3, v3, v7
    s_waitcnt vmcnt(26)
    buffer_store_dwordx4 v[72:75], v3, s[16:19], s22 offen

    v_add_u32 v2, 1088, v0
    v_mul_u32_u24 v3, 1214, v2
    v_lshrrev_b32 v3, 18, v3
    v_mul_u32_u24 v4, 216, v3
    v_sub_u32 v4, v2, v4
    v_mul_u32_u24 v5, 911, v4
    v_lshrrev_b32 v5, 16, v5
    v_mul_u32_u24 v6, 72, v5
    v_sub_u32 v6, v4, v6
    v_mul_u32_u24 v7, 3641, v6
    v_lshrrev_b32 v7, 16, v7
    v_mul_u32_u24 v120, 18, v7
    v_sub_u32 v6, v6, v120
    v_mul_u32_u24 v5, 18, v5
    v_add_u32 v6, v6, v5
    v_mul_u32_u24 v3, 864, v3
    v_lshl_add_u32 v3, v6, 4, v3
    s_mov_b32 s24, 497664
    v_mul_lo_u32 v7, v7, s24
    v_add_u32 v3, v3, v7
    s_waitcnt vmcnt(26)
    buffer_store_dwordx4 v[76:79], v3, s[16:19], s22 offen

    v_add_u32 v2, 1152, v0
    v_mul_u32_u24 v3, 1214, v2
    v_lshrrev_b32 v3, 18, v3
    v_mul_u32_u24 v4, 216, v3
    v_sub_u32 v4, v2, v4
    v_mul_u32_u24 v5, 911, v4
    v_lshrrev_b32 v5, 16, v5
    v_mul_u32_u24 v6, 72, v5
    v_sub_u32 v6, v4, v6
    v_mul_u32_u24 v7, 3641, v6
    v_lshrrev_b32 v7, 16, v7
    v_mul_u32_u24 v120, 18, v7
    v_sub_u32 v6, v6, v120
    v_mul_u32_u24 v5, 18, v5
    v_add_u32 v6, v6, v5
    v_mul_u32_u24 v3, 864, v3
    v_lshl_add_u32 v3, v6, 4, v3
    s_mov_b32 s24, 497664
    v_mul_lo_u32 v7, v7, s24
    v_add_u32 v3, v3, v7
    s_waitcnt vmcnt(26)
    buffer_store_dwordx4 v[80:83], v3, s[16:19], s22 offen

    v_add_u32 v2, 1216, v0
    v_mul_u32_u24 v3, 1214, v2
    v_lshrrev_b32 v3, 18, v3
    v_mul_u32_u24 v4, 216, v3
    v_sub_u32 v4, v2, v4
    v_mul_u32_u24 v5, 911, v4
    v_lshrrev_b32 v5, 16, v5
    v_mul_u32_u24 v6, 72, v5
    v_sub_u32 v6, v4, v6
    v_mul_u32_u24 v7, 3641, v6
    v_lshrrev_b32 v7, 16, v7
    v_mul_u32_u24 v120, 18, v7
    v_sub_u32 v6, v6, v120
    v_mul_u32_u24 v5, 18, v5
    v_add_u32 v6, v6, v5
    v_mul_u32_u24 v3, 864, v3
    v_lshl_add_u32 v3, v6, 4, v3
    s_mov_b32 s24, 497664
    v_mul_lo_u32 v7, v7, s24
    v_add_u32 v3, v3, v7
    s_waitcnt vmcnt(26)
    buffer_store_dwordx4 v[84:87], v3, s[16:19], s22 offen

    v_add_u32 v2, 1280, v0
    v_mul_u32_u24 v3, 1214, v2
    v_lshrrev_b32 v3, 18, v3
    v_mul_u32_u24 v4, 216, v3
    v_sub_u32 v4, v2, v4
    v_mul_u32_u24 v5, 911, v4
    v_lshrrev_b32 v5, 16, v5
    v_mul_u32_u24 v6, 72, v5
    v_sub_u32 v6, v4, v6
    v_mul_u32_u24 v7, 3641, v6
    v_lshrrev_b32 v7, 16, v7
    v_mul_u32_u24 v120, 18, v7
    v_sub_u32 v6, v6, v120
    v_mul_u32_u24 v5, 18, v5
    v_add_u32 v6, v6, v5
    v_mul_u32_u24 v3, 864, v3
    v_lshl_add_u32 v3, v6, 4, v3
    s_mov_b32 s24, 497664
    v_mul_lo_u32 v7, v7, s24
    v_add_u32 v3, v3, v7
    s_waitcnt vmcnt(26)
    buffer_store_dwordx4 v[88:91], v3, s[16:19], s22 offen

    v_add_u32 v2, 1344, v0
    v_mul_u32_u24 v3, 1214, v2
    v_lshrrev_b32 v3, 18, v3
    v_mul_u32_u24 v4, 216, v3
    v_sub_u32 v4, v2, v4
    v_mul_u32_u24 v5, 911, v4
    v_lshrrev_b32 v5, 16, v5
    v_mul_u32_u24 v6, 72, v5
    v_sub_u32 v6, v4, v6
    v_mul_u32_u24 v7, 3641, v6
    v_lshrrev_b32 v7, 16, v7
    v_mul_u32_u24 v120, 18, v7
    v_sub_u32 v6, v6, v120
    v_mul_u32_u24 v5, 18, v5
    v_add_u32 v6, v6, v5
    v_mul_u32_u24 v3, 864, v3
    v_lshl_add_u32 v3, v6, 4, v3
    s_mov_b32 s24, 497664
    v_mul_lo_u32 v7, v7, s24
    v_add_u32 v3, v3, v7
    s_waitcnt vmcnt(26)
    buffer_store_dwordx4 v[92:95], v3, s[16:19], s22 offen

    v_add_u32 v2, 1408, v0
    v_mul_u32_u24 v3, 1214, v2
    v_lshrrev_b32 v3, 18, v3
    v_mul_u32_u24 v4, 216, v3
    v_sub_u32 v4, v2, v4
    v_mul_u32_u24 v5, 911, v4
    v_lshrrev_b32 v5, 16, v5
    v_mul_u32_u24 v6, 72, v5
    v_sub_u32 v6, v4, v6
    v_mul_u32_u24 v7, 3641, v6
    v_lshrrev_b32 v7, 16, v7
    v_mul_u32_u24 v120, 18, v7
    v_sub_u32 v6, v6, v120
    v_mul_u32_u24 v5, 18, v5
    v_add_u32 v6, v6, v5
    v_mul_u32_u24 v3, 864, v3
    v_lshl_add_u32 v3, v6, 4, v3
    s_mov_b32 s24, 497664
    v_mul_lo_u32 v7, v7, s24
    v_add_u32 v3, v3, v7
    s_waitcnt vmcnt(26)
    buffer_store_dwordx4 v[96:99], v3, s[16:19], s22 offen

    v_add_u32 v2, 1472, v0
    v_mul_u32_u24 v3, 1214, v2
    v_lshrrev_b32 v3, 18, v3
    v_mul_u32_u24 v4, 216, v3
    v_sub_u32 v4, v2, v4
    v_mul_u32_u24 v5, 911, v4
    v_lshrrev_b32 v5, 16, v5
    v_mul_u32_u24 v6, 72, v5
    v_sub_u32 v6, v4, v6
    v_mul_u32_u24 v7, 3641, v6
    v_lshrrev_b32 v7, 16, v7
    v_mul_u32_u24 v120, 18, v7
    v_sub_u32 v6, v6, v120
    v_mul_u32_u24 v5, 18, v5
    v_add_u32 v6, v6, v5
    v_mul_u32_u24 v3, 864, v3
    v_lshl_add_u32 v3, v6, 4, v3
    s_mov_b32 s24, 497664
    v_mul_lo_u32 v7, v7, s24
    v_add_u32 v3, v3, v7
    s_waitcnt vmcnt(26)
    buffer_store_dwordx4 v[100:103], v3, s[16:19], s22 offen

    v_add_u32 v2, 1536, v0
    v_mul_u32_u24 v3, 1214, v2
    v_lshrrev_b32 v3, 18, v3
    v_mul_u32_u24 v4, 216, v3
    v_sub_u32 v4, v2, v4
    v_mul_u32_u24 v5, 911, v4
    v_lshrrev_b32 v5, 16, v5
    v_mul_u32_u24 v6, 72, v5
    v_sub_u32 v6, v4, v6
    v_mul_u32_u24 v7, 3641, v6
    v_lshrrev_b32 v7, 16, v7
    v_mul_u32_u24 v120, 18, v7
    v_sub_u32 v6, v6, v120
    v_mul_u32_u24 v5, 18, v5
    v_add_u32 v6, v6, v5
    v_mul_u32_u24 v3, 864, v3
    v_lshl_add_u32 v3, v6, 4, v3
    s_mov_b32 s24, 497664
    v_mul_lo_u32 v7, v7, s24
    v_add_u32 v3, v3, v7
    s_waitcnt vmcnt(26)
    buffer_store_dwordx4 v[104:107], v3, s[16:19], s22 offen

    v_add_u32 v2, 1600, v0
    v_mul_u32_u24 v3, 1214, v2
    v_lshrrev_b32 v3, 18, v3
    v_mul_u32_u24 v4, 216, v3
    v_sub_u32 v4, v2, v4
    v_mul_u32_u24 v5, 911, v4
    v_lshrrev_b32 v5, 16, v5
    v_mul_u32_u24 v6, 72, v5
    v_sub_u32 v6, v4, v6
    v_mul_u32_u24 v7, 3641, v6
    v_lshrrev_b32 v7, 16, v7
    v_mul_u32_u24 v120, 18, v7
    v_sub_u32 v6, v6, v120
    v_mul_u32_u24 v5, 18, v5
    v_add_u32 v6, v6, v5
    v_mul_u32_u24 v3, 864, v3
    v_lshl_add_u32 v3, v6, 4, v3
    s_mov_b32 s24, 497664
    v_mul_lo_u32 v7, v7, s24
    v_add_u32 v3, v3, v7
    s_waitcnt vmcnt(26)
    buffer_store_dwordx4 v[108:111], v3, s[16:19], s22 offen

    v_add_u32 v2, 1664, v0
    v_mul_u32_u24 v3, 1214, v2
    v_lshrrev_b32 v3, 18, v3
    v_mul_u32_u24 v4, 216, v3
    v_sub_u32 v4, v2, v4
    v_mul_u32_u24 v5, 911, v4
    v_lshrrev_b32 v5, 16, v5
    v_mul_u32_u24 v6, 72, v5
    v_sub_u32 v6, v4, v6
    v_mul_u32_u24 v7, 3641, v6
    v_lshrrev_b32 v7, 16, v7
    v_mul_u32_u24 v120, 18, v7
    v_sub_u32 v6, v6, v120
    v_mul_u32_u24 v5, 18, v5
    v_add_u32 v6, v6, v5
    v_mul_u32_u24 v3, 864, v3
    v_lshl_add_u32 v3, v6, 4, v3
    s_mov_b32 s24, 497664
    v_mul_lo_u32 v7, v7, s24
    v_add_u32 v3, v3, v7
    s_waitcnt vmcnt(26)
    buffer_store_dwordx4 v[112:115], v3, s[16:19], s22 offen

    s_endpgm
.globl g1_kernel
.p2align 8
.type g1_kernel,@function
g1_kernel:
    s_cmp_ge_u32 s2, 256
    s_cbranch_scc1 G1_END
    s_load_dwordx2 s[4:5], s[0:1], 72
    s_load_dwordx2 s[6:7], s[0:1], 32
    s_load_dwordx2 s[8:9], s[0:1], 40
    s_load_dwordx2 s[10:11], s[0:1], 8
    v_lshrrev_b32 v1, 6, v0
    v_and_b32 v0, 63, v0
    s_nop 0
    v_readfirstlane_b32 s3, v1
    s_waitcnt lgkmcnt(0)

    s_mov_b32 s12, s4
    s_mov_b32 s13, s5
    s_mov_b32 s14, 0x240000
    s_mov_b32 s15, 0x00020000
    s_add_u32 s16, s4, 0x400000
    s_addc_u32 s17, s5, 0
    s_mov_b32 s18, 0x1440000
    s_mov_b32 s19, 0x00020000
    s_cmp_ge_u32 s2, 192
    s_cbranch_scc1 QKV_ROLE

    s_lshr_b32 s20, s2, 3
    s_and_b32 s20, s20, 7
    s_and_b32 s21, s2, 7
    s_mul_i32 s21, s21, 3
    s_lshr_b32 s22, s2, 6
    s_add_u32 s21, s21, s22
    s_lshr_b32 s22, s3, 1
    s_and_b32 s23, s3, 1

    s_cmp_ge_u32 s3, 4
    s_cselect_b32 s24, s8, s6
    s_cselect_b32 s25, s9, s7
    s_mov_b32 s26, 5308416
    s_mov_b32 s27, 0x00020000

    s_lshl_b32 s28, s20, 14
    s_lshl_b32 s36, s3, 11
    s_add_u32 s28, s28, s36
    s_mov_b32 s30, s36
    s_and_b32 s36, s3, 3
    s_mul_i32 s29, s36, 73728
    s_mul_i32 s37, s21, 384
    s_add_u32 s29, s29, s37
    s_mul_i32 s31, s36, 3072
    s_lshr_b32 s37, s3, 2
    s_mul_i32 s37, s37, 12288
    s_add_u32 s31, s31, s37
    s_add_u32 s31, s31, 16384

    v_lshrrev_b32 v10, 2, v0
    v_and_b32 v11, 3, v0
    v_lshrrev_b32 v12, 4, v0
    v_xor_b32 v11, v11, v12
    v_lshlrev_b32 v2, 6, v10
    v_lshl_add_u32 v2, v11, 4, v2

    v_add_u32 v10, 0, v0
    v_mul_u32_u24 v11, 2731, v10
    v_lshrrev_b32 v11, 16, v11
    v_mul_u32_u24 v12, 24, v11
    v_sub_u32 v12, v10, v12
    v_lshrrev_b32 v13, 1, v11
    v_and_b32 v13, 1, v13
    v_lshlrev_b32 v13, 2, v13
    v_xor_b32 v12, v12, v13
    v_mul_u32_u24 v11, 9216, v11
    v_lshl_add_u32 v3, v12, 4, v11

    v_add_u32 v10, 64, v0
    v_mul_u32_u24 v11, 2731, v10
    v_lshrrev_b32 v11, 16, v11
    v_mul_u32_u24 v12, 24, v11
    v_sub_u32 v12, v10, v12
    v_lshrrev_b32 v13, 1, v11
    v_and_b32 v13, 1, v13
    v_lshlrev_b32 v13, 2, v13
    v_xor_b32 v12, v12, v13
    v_mul_u32_u24 v11, 9216, v11
    v_lshl_add_u32 v4, v12, 4, v11

    v_subrev_u32 v4, 1024, v4
    v_add_u32 v10, 128, v0
    v_mul_u32_u24 v11, 2731, v10
    v_lshrrev_b32 v11, 16, v11
    v_mul_u32_u24 v12, 24, v11
    v_sub_u32 v12, v10, v12
    v_lshrrev_b32 v13, 1, v11
    v_and_b32 v13, 1, v13
    v_lshlrev_b32 v13, 2, v13
    v_xor_b32 v12, v12, v13
    v_mul_u32_u24 v11, 9216, v11
    v_lshl_add_u32 v5, v12, 4, v11

    v_subrev_u32 v5, 2048, v5
    v_and_b32 v10, 31, v0
    s_lshl_b32 s36, s22, 6
    v_add_u32 v10, s36, v10
    v_lshrrev_b32 v11, 5, v0
    v_lshrrev_b32 v12, 2, v0
    v_and_b32 v12, 3, v12
    v_xor_b32 v13, v11, v12
    v_lshlrev_b32 v6, 6, v10
    v_lshl_add_u32 v6, v13, 4, v6
    v_xor_b32 v7, 32, v6

    v_lshrrev_b32 v13, 4, v0
    v_and_b32 v13, 1, v13
    v_and_b32 v14, 3, v0
    v_lshl_add_u32 v13, v13, 2, v14
    v_and_b32 v14, 1, v13
    v_lshrrev_b32 v15, 1, v13
    v_lshrrev_b32 v16, 1, v15
    v_and_b32 v15, 1, v15
    v_lshl_add_u32 v14, v14, 1, v16
    v_lshl_add_u32 v14, v15, 2, v14
    v_lshl_add_u32 v15, v11, 2, v12
    v_mul_u32_u24 v15, 384, v15
    v_lshl_add_u32 v15, v14, 3, v15
    s_mul_i32 s36, s23, 192
    s_add_u32 s36, s36, 16384
    v_add_u32 v15, s36, v15
    v_lshrrev_b32 v16, 1, v12
    v_lshlrev_b32 v16, 6, v16
    s_cmp_eq_u32 s23, 0
    s_cselect_b32 s36, 1, -1
    v_mul_lo_u32 v16, v16, s36
    v_add_u32 v8, v15, v16
    v_sub_u32 v9, v15, v16

    s_mov_b32 s32, 0
    s_add_u32 m0, s32, s30
    s_nop 0
    buffer_load_dwordx4 v2, s[12:15], s28 offen lds
    buffer_load_dwordx4 v2, s[12:15], s28 offen offset:1024 lds
    s_add_u32 s28, s28, 131072
    s_add_u32 m0, s32, s31
    s_nop 0
    buffer_load_dwordx4 v3, s[24:27], s29 offen lds
    buffer_load_dwordx4 v4, s[24:27], s29 offen offset:1024 lds
    buffer_load_dwordx4 v5, s[24:27], s29 offen offset:2048 lds
    s_add_u32 s29, s29, 294912
    v_mov_b32 v64, 0
    v_mov_b32 v65, 0
    v_mov_b32 v66, 0
    v_mov_b32 v67, 0
    v_mov_b32 v68, 0
    v_mov_b32 v69, 0
    v_mov_b32 v70, 0
    v_mov_b32 v71, 0
    v_mov_b32 v72, 0
    v_mov_b32 v73, 0
    v_mov_b32 v74, 0
    v_mov_b32 v75, 0
    v_mov_b32 v76, 0
    v_mov_b32 v77, 0
    v_mov_b32 v78, 0
    v_mov_b32 v79, 0
    v_mov_b32 v80, 0
    v_mov_b32 v81, 0
    v_mov_b32 v82, 0
    v_mov_b32 v83, 0
    v_mov_b32 v84, 0
    v_mov_b32 v85, 0
    v_mov_b32 v86, 0
    v_mov_b32 v87, 0
    v_mov_b32 v88, 0
    v_mov_b32 v89, 0
    v_mov_b32 v90, 0
    v_mov_b32 v91, 0
    v_mov_b32 v92, 0
    v_mov_b32 v93, 0
    v_mov_b32 v94, 0
    v_mov_b32 v95, 0
    v_mov_b32 v96, 0
    v_mov_b32 v97, 0
    v_mov_b32 v98, 0
    v_mov_b32 v99, 0
    v_mov_b32 v100, 0
    v_mov_b32 v101, 0
    v_mov_b32 v102, 0
    v_mov_b32 v103, 0
    v_mov_b32 v104, 0
    v_mov_b32 v105, 0
    v_mov_b32 v106, 0
    v_mov_b32 v107, 0
    v_mov_b32 v108, 0
    v_mov_b32 v109, 0
    v_mov_b32 v110, 0
    v_mov_b32 v111, 0
    v_mov_b32 v112, 0
    v_mov_b32 v113, 0
    v_mov_b32 v114, 0
    v_mov_b32 v115, 0
    v_mov_b32 v116, 0
    v_mov_b32 v117, 0
    v_mov_b32 v118, 0
    v_mov_b32 v119, 0
    v_mov_b32 v120, 0
    v_mov_b32 v121, 0
    v_mov_b32 v122, 0
    v_mov_b32 v123, 0
    v_mov_b32 v124, 0
    v_mov_b32 v125, 0
    v_mov_b32 v126, 0
    v_mov_b32 v127, 0
    v_mov_b32 v128, 0
    v_mov_b32 v129, 0
    v_mov_b32 v130, 0
    v_mov_b32 v131, 0
    v_mov_b32 v132, 0
    v_mov_b32 v133, 0
    v_mov_b32 v134, 0
    v_mov_b32 v135, 0
    v_mov_b32 v136, 0
    v_mov_b32 v137, 0
    v_mov_b32 v138, 0
    v_mov_b32 v139, 0
    v_mov_b32 v140, 0
    v_mov_b32 v141, 0
    v_mov_b32 v142, 0
    v_mov_b32 v143, 0
    v_mov_b32 v144, 0
    v_mov_b32 v145, 0
    v_mov_b32 v146, 0
    v_mov_b32 v147, 0
    v_mov_b32 v148, 0
    v_mov_b32 v149, 0
    v_mov_b32 v150, 0
    v_mov_b32 v151, 0
    v_mov_b32 v152, 0
    v_mov_b32 v153, 0
    v_mov_b32 v154, 0
    v_mov_b32 v155, 0
    v_mov_b32 v156, 0
    v_mov_b32 v157, 0
    v_mov_b32 v158, 0
    v_mov_b32 v159, 0
    v_mov_b32 v160, 0
    v_mov_b32 v161, 0
    v_mov_b32 v162, 0
    v_mov_b32 v163, 0
    v_mov_b32 v164, 0
    v_mov_b32 v165, 0
    v_mov_b32 v166, 0
    v_mov_b32 v167, 0
    v_mov_b32 v168, 0
    v_mov_b32 v169, 0
    v_mov_b32 v170, 0
    v_mov_b32 v171, 0
    v_mov_b32 v172, 0
    v_mov_b32 v173, 0
    v_mov_b32 v174, 0
    v_mov_b32 v175, 0
    v_mov_b32 v176, 0
    v_mov_b32 v177, 0
    v_mov_b32 v178, 0
    v_mov_b32 v179, 0
    v_mov_b32 v180, 0
    v_mov_b32 v181, 0
    v_mov_b32 v182, 0
    v_mov_b32 v183, 0
    v_mov_b32 v184, 0
    v_mov_b32 v185, 0
    v_mov_b32 v186, 0
    v_mov_b32 v187, 0
    v_mov_b32 v188, 0
    v_mov_b32 v189, 0
    v_mov_b32 v190, 0
    v_mov_b32 v191, 0
    v_mov_b32 v192, 0
    v_mov_b32 v193, 0
    v_mov_b32 v194, 0
    v_mov_b32 v195, 0
    v_mov_b32 v196, 0
    v_mov_b32 v197, 0
    v_mov_b32 v198, 0
    v_mov_b32 v199, 0
    v_mov_b32 v200, 0
    v_mov_b32 v201, 0
    v_mov_b32 v202, 0
    v_mov_b32 v203, 0
    v_mov_b32 v204, 0
    v_mov_b32 v205, 0
    v_mov_b32 v206, 0
    v_mov_b32 v207, 0
    v_mov_b32 v208, 0
    v_mov_b32 v209, 0
    v_mov_b32 v210, 0
    v_mov_b32 v211, 0
    v_mov_b32 v212, 0
    v_mov_b32 v213, 0
    v_mov_b32 v214, 0
    v_mov_b32 v215, 0
    v_mov_b32 v216, 0
    v_mov_b32 v217, 0
    v_mov_b32 v218, 0
    v_mov_b32 v219, 0
    v_mov_b32 v220, 0
    v_mov_b32 v221, 0
    v_mov_b32 v222, 0
    v_mov_b32 v223, 0
    v_mov_b32 v224, 0
    v_mov_b32 v225, 0
    v_mov_b32 v226, 0
    v_mov_b32 v227, 0
    v_mov_b32 v228, 0
    v_mov_b32 v229, 0
    v_mov_b32 v230, 0
    v_mov_b32 v231, 0
    v_mov_b32 v232, 0
    v_mov_b32 v233, 0
    v_mov_b32 v234, 0
    v_mov_b32 v235, 0
    v_mov_b32 v236, 0
    v_mov_b32 v237, 0
    v_mov_b32 v238, 0
    v_mov_b32 v239, 0
    v_mov_b32 v240, 0
    v_mov_b32 v241, 0
    v_mov_b32 v242, 0
    v_mov_b32 v243, 0
    v_mov_b32 v244, 0
    v_mov_b32 v245, 0
    v_mov_b32 v246, 0
    v_mov_b32 v247, 0
    v_mov_b32 v248, 0
    v_mov_b32 v249, 0
    v_mov_b32 v250, 0
    v_mov_b32 v251, 0
    v_mov_b32 v252, 0
    v_mov_b32 v253, 0
    v_mov_b32 v254, 0
    v_mov_b32 v255, 0
    s_mov_b32 s32, 40960
    s_add_u32 m0, s32, s30
    s_nop 0
    buffer_load_dwordx4 v2, s[12:15], s28 offen lds
    buffer_load_dwordx4 v2, s[12:15], s28 offen offset:1024 lds
    s_add_u32 s28, s28, 131072
    s_add_u32 m0, s32, s31
    s_nop 0
    buffer_load_dwordx4 v3, s[24:27], s29 offen lds
    buffer_load_dwordx4 v4, s[24:27], s29 offen offset:1024 lds
    buffer_load_dwordx4 v5, s[24:27], s29 offen offset:2048 lds
    s_add_u32 s29, s29, 294912
    s_mov_b32 s32, 81920
    s_add_u32 m0, s32, s30
    s_nop 0
    buffer_load_dwordx4 v2, s[12:15], s28 offen lds
    buffer_load_dwordx4 v2, s[12:15], s28 offen offset:1024 lds
    s_add_u32 s28, s28, 131072
    s_add_u32 m0, s32, s31
    s_nop 0
    buffer_load_dwordx4 v3, s[24:27], s29 offen lds
    buffer_load_dwordx4 v4, s[24:27], s29 offen offset:1024 lds
    buffer_load_dwordx4 v5, s[24:27], s29 offen offset:2048 lds
    s_add_u32 s29, s29, 294912
    s_mov_b32 s32, 122880
    s_mov_b32 s33, 0
    s_waitcnt vmcnt(10)
    s_barrier
    v_add_u32 v10, s33, v6
    v_add_u32 v11, s33, v7
    v_add_u32 v12, s33, v8
    v_add_u32 v13, s33, v9

    ds_read_b128 v[40:43], v10
    ds_read_b128 v[44:47], v10 offset:2048
    ds_read_b64_tr_b16 v[16:17], v12 offset:0
    ds_read_b64_tr_b16 v[18:19], v12 offset:6144
    ds_read_b64_tr_b16 v[20:21], v13 offset:64
    ds_read_b64_tr_b16 v[22:23], v13 offset:6208
    ds_read_b64_tr_b16 v[24:25], v12 offset:128
    ds_read_b64_tr_b16 v[26:27], v12 offset:6272
    ds_read_b64_tr_b16 v[28:29], v12 offset:12288
    ds_read_b64_tr_b16 v[30:31], v12 offset:18432
    ds_read_b64_tr_b16 v[32:33], v13 offset:12352
    ds_read_b64_tr_b16 v[34:35], v13 offset:18496
    ds_read_b64_tr_b16 v[36:37], v12 offset:12416
    ds_read_b64_tr_b16 v[38:39], v12 offset:18560
    s_mov_b32 s34, 0
GU_LOOP:
    ds_read_b128 v[48:51], v11
    ds_read_b128 v[52:55], v11 offset:2048
    s_waitcnt lgkmcnt(12)
    v_mfma_f32_32x32x16_bf16 v[64:79], v[16:19], v[40:43], v[64:79]
    v_mfma_f32_32x32x16_bf16 v[80:95], v[16:19], v[44:47], v[80:95]
    ds_read_b64_tr_b16 v[16:17], v12 offset:3072
    ds_read_b64_tr_b16 v[18:19], v12 offset:9216
    s_waitcnt lgkmcnt(12)
    v_mfma_f32_32x32x16_bf16 v[96:111], v[20:23], v[40:43], v[96:111]
    v_mfma_f32_32x32x16_bf16 v[112:127], v[20:23], v[44:47], v[112:127]
    ds_read_b64_tr_b16 v[20:21], v13 offset:3136
    ds_read_b64_tr_b16 v[22:23], v13 offset:9280
    s_waitcnt lgkmcnt(12)
    v_mfma_f32_32x32x16_bf16 v[128:143], v[24:27], v[40:43], v[128:143]
    v_mfma_f32_32x32x16_bf16 v[144:159], v[24:27], v[44:47], v[144:159]
    ds_read_b64_tr_b16 v[24:25], v12 offset:3200
    ds_read_b64_tr_b16 v[26:27], v12 offset:9344
    s_waitcnt lgkmcnt(12)
    v_mfma_f32_32x32x16_bf16 v[160:175], v[28:31], v[40:43], v[160:175]
    v_mfma_f32_32x32x16_bf16 v[176:191], v[28:31], v[44:47], v[176:191]
    ds_read_b64_tr_b16 v[28:29], v12 offset:15360
    ds_read_b64_tr_b16 v[30:31], v12 offset:21504
    s_waitcnt lgkmcnt(12)
    v_mfma_f32_32x32x16_bf16 v[192:207], v[32:35], v[40:43], v[192:207]
    v_mfma_f32_32x32x16_bf16 v[208:223], v[32:35], v[44:47], v[208:223]
    ds_read_b64_tr_b16 v[32:33], v13 offset:15424
    ds_read_b64_tr_b16 v[34:35], v13 offset:21568
    s_waitcnt lgkmcnt(12)
    v_mfma_f32_32x32x16_bf16 v[224:239], v[36:39], v[40:43], v[224:239]
    v_mfma_f32_32x32x16_bf16 v[240:255], v[36:39], v[44:47], v[240:255]
    ds_read_b64_tr_b16 v[36:37], v12 offset:15488
    ds_read_b64_tr_b16 v[38:39], v12 offset:21632
    s_waitcnt vmcnt(5)
    s_barrier
    s_add_u32 s33, s33, 40960
    s_cmp_eq_u32 s33, 163840
    s_cselect_b32 s33, 0, s33

    v_add_u32 v10, s33, v6
    v_add_u32 v11, s33, v7
    v_add_u32 v12, s33, v8
    v_add_u32 v13, s33, v9

    ds_read_b128 v[40:43], v10
    ds_read_b128 v[44:47], v10 offset:2048
    s_waitcnt lgkmcnt(12)
    v_mfma_f32_32x32x16_bf16 v[64:79], v[16:19], v[48:51], v[64:79]
    v_mfma_f32_32x32x16_bf16 v[80:95], v[16:19], v[52:55], v[80:95]
    ds_read_b64_tr_b16 v[16:17], v12 offset:0
    ds_read_b64_tr_b16 v[18:19], v12 offset:6144
    s_add_u32 m0, s32, s30
    s_nop 0
    buffer_load_dwordx4 v2, s[12:15], s28 offen lds
    s_waitcnt lgkmcnt(12)
    v_mfma_f32_32x32x16_bf16 v[96:111], v[20:23], v[48:51], v[96:111]
    v_mfma_f32_32x32x16_bf16 v[112:127], v[20:23], v[52:55], v[112:127]
    ds_read_b64_tr_b16 v[20:21], v13 offset:64
    ds_read_b64_tr_b16 v[22:23], v13 offset:6208
    buffer_load_dwordx4 v2, s[12:15], s28 offen offset:1024 lds
    s_add_u32 s28, s28, 131072
    s_waitcnt lgkmcnt(12)
    v_mfma_f32_32x32x16_bf16 v[128:143], v[24:27], v[48:51], v[128:143]
    v_mfma_f32_32x32x16_bf16 v[144:159], v[24:27], v[52:55], v[144:159]
    ds_read_b64_tr_b16 v[24:25], v12 offset:128
    ds_read_b64_tr_b16 v[26:27], v12 offset:6272
    s_add_u32 m0, s32, s31
    s_nop 0
    buffer_load_dwordx4 v3, s[24:27], s29 offen lds
    s_waitcnt lgkmcnt(12)
    v_mfma_f32_32x32x16_bf16 v[160:175], v[28:31], v[48:51], v[160:175]
    v_mfma_f32_32x32x16_bf16 v[176:191], v[28:31], v[52:55], v[176:191]
    ds_read_b64_tr_b16 v[28:29], v12 offset:12288
    ds_read_b64_tr_b16 v[30:31], v12 offset:18432
    buffer_load_dwordx4 v4, s[24:27], s29 offen offset:1024 lds
    s_waitcnt lgkmcnt(12)
    v_mfma_f32_32x32x16_bf16 v[192:207], v[32:35], v[48:51], v[192:207]
    v_mfma_f32_32x32x16_bf16 v[208:223], v[32:35], v[52:55], v[208:223]
    ds_read_b64_tr_b16 v[32:33], v13 offset:12352
    ds_read_b64_tr_b16 v[34:35], v13 offset:18496
    buffer_load_dwordx4 v5, s[24:27], s29 offen offset:2048 lds
    s_add_u32 s29, s29, 294912
    s_waitcnt lgkmcnt(12)
    v_mfma_f32_32x32x16_bf16 v[224:239], v[36:39], v[48:51], v[224:239]
    v_mfma_f32_32x32x16_bf16 v[240:255], v[36:39], v[52:55], v[240:255]
    ds_read_b64_tr_b16 v[36:37], v12 offset:12416
    ds_read_b64_tr_b16 v[38:39], v12 offset:18560
    s_add_u32 s32, s32, 40960
    s_cmp_eq_u32 s32, 163840
    s_cselect_b32 s32, 0, s32

    s_add_u32 s34, s34, 1
    s_cmp_lt_u32 s34, 18
    s_cbranch_scc1 GU_LOOP

    s_waitcnt lgkmcnt(0)
    s_nop 15

    v_and_b32 v10, 31, v0
    s_lshl_b32 s36, s20, 8
    s_lshl_b32 s37, s22, 6
    s_add_u32 s36, s36, s37
    v_add_u32 v10, s36, v10
    v_lshlrev_b32 v10, 6, v10
    v_lshrrev_b32 v11, 5, v0
    v_lshl_add_u32 v10, v11, 5, v10
    s_mul_i32 s36, s21, 6
    s_mul_i32 s37, s23, 3
    s_add_u32 s36, s36, s37
    s_lshl_b32 s36, s36, 17

    v_cvt_pk_bf16_f32 v32, v64, v65
    v_cvt_pk_bf16_f32 v33, v160, v161
    v_pk_max_i16 v32, v32, 0
    v_lshlrev_b32 v34, 16, v32
    v_and_b32 v35, 0xffff0000, v32
    v_lshlrev_b32 v36, 16, v33
    v_and_b32 v37, 0xffff0000, v33
    v_mul_f32 v34, v34, v36
    v_mul_f32 v35, v35, v37
    v_cvt_pk_bf16_f32 v16, v34, v35

    v_cvt_pk_bf16_f32 v32, v66, v67
    v_cvt_pk_bf16_f32 v33, v162, v163
    v_pk_max_i16 v32, v32, 0
    v_lshlrev_b32 v34, 16, v32
    v_and_b32 v35, 0xffff0000, v32
    v_lshlrev_b32 v36, 16, v33
    v_and_b32 v37, 0xffff0000, v33
    v_mul_f32 v34, v34, v36
    v_mul_f32 v35, v35, v37
    v_cvt_pk_bf16_f32 v17, v34, v35

    v_cvt_pk_bf16_f32 v32, v68, v69
    v_cvt_pk_bf16_f32 v33, v164, v165
    v_pk_max_i16 v32, v32, 0
    v_lshlrev_b32 v34, 16, v32
    v_and_b32 v35, 0xffff0000, v32
    v_lshlrev_b32 v36, 16, v33
    v_and_b32 v37, 0xffff0000, v33
    v_mul_f32 v34, v34, v36
    v_mul_f32 v35, v35, v37
    v_cvt_pk_bf16_f32 v18, v34, v35

    v_cvt_pk_bf16_f32 v32, v70, v71
    v_cvt_pk_bf16_f32 v33, v166, v167
    v_pk_max_i16 v32, v32, 0
    v_lshlrev_b32 v34, 16, v32
    v_and_b32 v35, 0xffff0000, v32
    v_lshlrev_b32 v36, 16, v33
    v_and_b32 v37, 0xffff0000, v33
    v_mul_f32 v34, v34, v36
    v_mul_f32 v35, v35, v37
    v_cvt_pk_bf16_f32 v19, v34, v35

    v_cvt_pk_bf16_f32 v32, v72, v73
    v_cvt_pk_bf16_f32 v33, v168, v169
    v_pk_max_i16 v32, v32, 0
    v_lshlrev_b32 v34, 16, v32
    v_and_b32 v35, 0xffff0000, v32
    v_lshlrev_b32 v36, 16, v33
    v_and_b32 v37, 0xffff0000, v33
    v_mul_f32 v34, v34, v36
    v_mul_f32 v35, v35, v37
    v_cvt_pk_bf16_f32 v20, v34, v35

    v_cvt_pk_bf16_f32 v32, v74, v75
    v_cvt_pk_bf16_f32 v33, v170, v171
    v_pk_max_i16 v32, v32, 0
    v_lshlrev_b32 v34, 16, v32
    v_and_b32 v35, 0xffff0000, v32
    v_lshlrev_b32 v36, 16, v33
    v_and_b32 v37, 0xffff0000, v33
    v_mul_f32 v34, v34, v36
    v_mul_f32 v35, v35, v37
    v_cvt_pk_bf16_f32 v21, v34, v35

    v_cvt_pk_bf16_f32 v32, v76, v77
    v_cvt_pk_bf16_f32 v33, v172, v173
    v_pk_max_i16 v32, v32, 0
    v_lshlrev_b32 v34, 16, v32
    v_and_b32 v35, 0xffff0000, v32
    v_lshlrev_b32 v36, 16, v33
    v_and_b32 v37, 0xffff0000, v33
    v_mul_f32 v34, v34, v36
    v_mul_f32 v35, v35, v37
    v_cvt_pk_bf16_f32 v22, v34, v35

    v_cvt_pk_bf16_f32 v32, v78, v79
    v_cvt_pk_bf16_f32 v33, v174, v175
    v_pk_max_i16 v32, v32, 0
    v_lshlrev_b32 v34, 16, v32
    v_and_b32 v35, 0xffff0000, v32
    v_lshlrev_b32 v36, 16, v33
    v_and_b32 v37, 0xffff0000, v33
    v_mul_f32 v34, v34, v36
    v_mul_f32 v35, v35, v37
    v_cvt_pk_bf16_f32 v23, v34, v35

    buffer_store_dwordx4 v[16:19], v10, s[16:19], s36 offen offset:0
    buffer_store_dwordx4 v[20:23], v10, s[16:19], s36 offen offset:16
    v_cvt_pk_bf16_f32 v32, v80, v81
    v_cvt_pk_bf16_f32 v33, v176, v177
    v_pk_max_i16 v32, v32, 0
    v_lshlrev_b32 v34, 16, v32
    v_and_b32 v35, 0xffff0000, v32
    v_lshlrev_b32 v36, 16, v33
    v_and_b32 v37, 0xffff0000, v33
    v_mul_f32 v34, v34, v36
    v_mul_f32 v35, v35, v37
    v_cvt_pk_bf16_f32 v24, v34, v35

    v_cvt_pk_bf16_f32 v32, v82, v83
    v_cvt_pk_bf16_f32 v33, v178, v179
    v_pk_max_i16 v32, v32, 0
    v_lshlrev_b32 v34, 16, v32
    v_and_b32 v35, 0xffff0000, v32
    v_lshlrev_b32 v36, 16, v33
    v_and_b32 v37, 0xffff0000, v33
    v_mul_f32 v34, v34, v36
    v_mul_f32 v35, v35, v37
    v_cvt_pk_bf16_f32 v25, v34, v35

    v_cvt_pk_bf16_f32 v32, v84, v85
    v_cvt_pk_bf16_f32 v33, v180, v181
    v_pk_max_i16 v32, v32, 0
    v_lshlrev_b32 v34, 16, v32
    v_and_b32 v35, 0xffff0000, v32
    v_lshlrev_b32 v36, 16, v33
    v_and_b32 v37, 0xffff0000, v33
    v_mul_f32 v34, v34, v36
    v_mul_f32 v35, v35, v37
    v_cvt_pk_bf16_f32 v26, v34, v35

    v_cvt_pk_bf16_f32 v32, v86, v87
    v_cvt_pk_bf16_f32 v33, v182, v183
    v_pk_max_i16 v32, v32, 0
    v_lshlrev_b32 v34, 16, v32
    v_and_b32 v35, 0xffff0000, v32
    v_lshlrev_b32 v36, 16, v33
    v_and_b32 v37, 0xffff0000, v33
    v_mul_f32 v34, v34, v36
    v_mul_f32 v35, v35, v37
    v_cvt_pk_bf16_f32 v27, v34, v35

    v_cvt_pk_bf16_f32 v32, v88, v89
    v_cvt_pk_bf16_f32 v33, v184, v185
    v_pk_max_i16 v32, v32, 0
    v_lshlrev_b32 v34, 16, v32
    v_and_b32 v35, 0xffff0000, v32
    v_lshlrev_b32 v36, 16, v33
    v_and_b32 v37, 0xffff0000, v33
    v_mul_f32 v34, v34, v36
    v_mul_f32 v35, v35, v37
    v_cvt_pk_bf16_f32 v28, v34, v35

    v_cvt_pk_bf16_f32 v32, v90, v91
    v_cvt_pk_bf16_f32 v33, v186, v187
    v_pk_max_i16 v32, v32, 0
    v_lshlrev_b32 v34, 16, v32
    v_and_b32 v35, 0xffff0000, v32
    v_lshlrev_b32 v36, 16, v33
    v_and_b32 v37, 0xffff0000, v33
    v_mul_f32 v34, v34, v36
    v_mul_f32 v35, v35, v37
    v_cvt_pk_bf16_f32 v29, v34, v35

    v_cvt_pk_bf16_f32 v32, v92, v93
    v_cvt_pk_bf16_f32 v33, v188, v189
    v_pk_max_i16 v32, v32, 0
    v_lshlrev_b32 v34, 16, v32
    v_and_b32 v35, 0xffff0000, v32
    v_lshlrev_b32 v36, 16, v33
    v_and_b32 v37, 0xffff0000, v33
    v_mul_f32 v34, v34, v36
    v_mul_f32 v35, v35, v37
    v_cvt_pk_bf16_f32 v30, v34, v35

    v_cvt_pk_bf16_f32 v32, v94, v95
    v_cvt_pk_bf16_f32 v33, v190, v191
    v_pk_max_i16 v32, v32, 0
    v_lshlrev_b32 v34, 16, v32
    v_and_b32 v35, 0xffff0000, v32
    v_lshlrev_b32 v36, 16, v33
    v_and_b32 v37, 0xffff0000, v33
    v_mul_f32 v34, v34, v36
    v_mul_f32 v35, v35, v37
    v_cvt_pk_bf16_f32 v31, v34, v35

    buffer_store_dwordx4 v[24:27], v10, s[16:19], s36 offen offset:2048
    buffer_store_dwordx4 v[28:31], v10, s[16:19], s36 offen offset:2064
    s_add_u32 s36, s36, 131072
    v_cvt_pk_bf16_f32 v32, v96, v97
    v_cvt_pk_bf16_f32 v33, v192, v193
    v_pk_max_i16 v32, v32, 0
    v_lshlrev_b32 v34, 16, v32
    v_and_b32 v35, 0xffff0000, v32
    v_lshlrev_b32 v36, 16, v33
    v_and_b32 v37, 0xffff0000, v33
    v_mul_f32 v34, v34, v36
    v_mul_f32 v35, v35, v37
    v_cvt_pk_bf16_f32 v16, v34, v35

    v_cvt_pk_bf16_f32 v32, v98, v99
    v_cvt_pk_bf16_f32 v33, v194, v195
    v_pk_max_i16 v32, v32, 0
    v_lshlrev_b32 v34, 16, v32
    v_and_b32 v35, 0xffff0000, v32
    v_lshlrev_b32 v36, 16, v33
    v_and_b32 v37, 0xffff0000, v33
    v_mul_f32 v34, v34, v36
    v_mul_f32 v35, v35, v37
    v_cvt_pk_bf16_f32 v17, v34, v35

    v_cvt_pk_bf16_f32 v32, v100, v101
    v_cvt_pk_bf16_f32 v33, v196, v197
    v_pk_max_i16 v32, v32, 0
    v_lshlrev_b32 v34, 16, v32
    v_and_b32 v35, 0xffff0000, v32
    v_lshlrev_b32 v36, 16, v33
    v_and_b32 v37, 0xffff0000, v33
    v_mul_f32 v34, v34, v36
    v_mul_f32 v35, v35, v37
    v_cvt_pk_bf16_f32 v18, v34, v35

    v_cvt_pk_bf16_f32 v32, v102, v103
    v_cvt_pk_bf16_f32 v33, v198, v199
    v_pk_max_i16 v32, v32, 0
    v_lshlrev_b32 v34, 16, v32
    v_and_b32 v35, 0xffff0000, v32
    v_lshlrev_b32 v36, 16, v33
    v_and_b32 v37, 0xffff0000, v33
    v_mul_f32 v34, v34, v36
    v_mul_f32 v35, v35, v37
    v_cvt_pk_bf16_f32 v19, v34, v35

    v_cvt_pk_bf16_f32 v32, v104, v105
    v_cvt_pk_bf16_f32 v33, v200, v201
    v_pk_max_i16 v32, v32, 0
    v_lshlrev_b32 v34, 16, v32
    v_and_b32 v35, 0xffff0000, v32
    v_lshlrev_b32 v36, 16, v33
    v_and_b32 v37, 0xffff0000, v33
    v_mul_f32 v34, v34, v36
    v_mul_f32 v35, v35, v37
    v_cvt_pk_bf16_f32 v20, v34, v35

    v_cvt_pk_bf16_f32 v32, v106, v107
    v_cvt_pk_bf16_f32 v33, v202, v203
    v_pk_max_i16 v32, v32, 0
    v_lshlrev_b32 v34, 16, v32
    v_and_b32 v35, 0xffff0000, v32
    v_lshlrev_b32 v36, 16, v33
    v_and_b32 v37, 0xffff0000, v33
    v_mul_f32 v34, v34, v36
    v_mul_f32 v35, v35, v37
    v_cvt_pk_bf16_f32 v21, v34, v35

    v_cvt_pk_bf16_f32 v32, v108, v109
    v_cvt_pk_bf16_f32 v33, v204, v205
    v_pk_max_i16 v32, v32, 0
    v_lshlrev_b32 v34, 16, v32
    v_and_b32 v35, 0xffff0000, v32
    v_lshlrev_b32 v36, 16, v33
    v_and_b32 v37, 0xffff0000, v33
    v_mul_f32 v34, v34, v36
    v_mul_f32 v35, v35, v37
    v_cvt_pk_bf16_f32 v22, v34, v35

    v_cvt_pk_bf16_f32 v32, v110, v111
    v_cvt_pk_bf16_f32 v33, v206, v207
    v_pk_max_i16 v32, v32, 0
    v_lshlrev_b32 v34, 16, v32
    v_and_b32 v35, 0xffff0000, v32
    v_lshlrev_b32 v36, 16, v33
    v_and_b32 v37, 0xffff0000, v33
    v_mul_f32 v34, v34, v36
    v_mul_f32 v35, v35, v37
    v_cvt_pk_bf16_f32 v23, v34, v35

    buffer_store_dwordx4 v[16:19], v10, s[16:19], s36 offen offset:0
    buffer_store_dwordx4 v[20:23], v10, s[16:19], s36 offen offset:16
    v_cvt_pk_bf16_f32 v32, v112, v113
    v_cvt_pk_bf16_f32 v33, v208, v209
    v_pk_max_i16 v32, v32, 0
    v_lshlrev_b32 v34, 16, v32
    v_and_b32 v35, 0xffff0000, v32
    v_lshlrev_b32 v36, 16, v33
    v_and_b32 v37, 0xffff0000, v33
    v_mul_f32 v34, v34, v36
    v_mul_f32 v35, v35, v37
    v_cvt_pk_bf16_f32 v24, v34, v35

    v_cvt_pk_bf16_f32 v32, v114, v115
    v_cvt_pk_bf16_f32 v33, v210, v211
    v_pk_max_i16 v32, v32, 0
    v_lshlrev_b32 v34, 16, v32
    v_and_b32 v35, 0xffff0000, v32
    v_lshlrev_b32 v36, 16, v33
    v_and_b32 v37, 0xffff0000, v33
    v_mul_f32 v34, v34, v36
    v_mul_f32 v35, v35, v37
    v_cvt_pk_bf16_f32 v25, v34, v35

    v_cvt_pk_bf16_f32 v32, v116, v117
    v_cvt_pk_bf16_f32 v33, v212, v213
    v_pk_max_i16 v32, v32, 0
    v_lshlrev_b32 v34, 16, v32
    v_and_b32 v35, 0xffff0000, v32
    v_lshlrev_b32 v36, 16, v33
    v_and_b32 v37, 0xffff0000, v33
    v_mul_f32 v34, v34, v36
    v_mul_f32 v35, v35, v37
    v_cvt_pk_bf16_f32 v26, v34, v35

    v_cvt_pk_bf16_f32 v32, v118, v119
    v_cvt_pk_bf16_f32 v33, v214, v215
    v_pk_max_i16 v32, v32, 0
    v_lshlrev_b32 v34, 16, v32
    v_and_b32 v35, 0xffff0000, v32
    v_lshlrev_b32 v36, 16, v33
    v_and_b32 v37, 0xffff0000, v33
    v_mul_f32 v34, v34, v36
    v_mul_f32 v35, v35, v37
    v_cvt_pk_bf16_f32 v27, v34, v35

    v_cvt_pk_bf16_f32 v32, v120, v121
    v_cvt_pk_bf16_f32 v33, v216, v217
    v_pk_max_i16 v32, v32, 0
    v_lshlrev_b32 v34, 16, v32
    v_and_b32 v35, 0xffff0000, v32
    v_lshlrev_b32 v36, 16, v33
    v_and_b32 v37, 0xffff0000, v33
    v_mul_f32 v34, v34, v36
    v_mul_f32 v35, v35, v37
    v_cvt_pk_bf16_f32 v28, v34, v35

    v_cvt_pk_bf16_f32 v32, v122, v123
    v_cvt_pk_bf16_f32 v33, v218, v219
    v_pk_max_i16 v32, v32, 0
    v_lshlrev_b32 v34, 16, v32
    v_and_b32 v35, 0xffff0000, v32
    v_lshlrev_b32 v36, 16, v33
    v_and_b32 v37, 0xffff0000, v33
    v_mul_f32 v34, v34, v36
    v_mul_f32 v35, v35, v37
    v_cvt_pk_bf16_f32 v29, v34, v35

    v_cvt_pk_bf16_f32 v32, v124, v125
    v_cvt_pk_bf16_f32 v33, v220, v221
    v_pk_max_i16 v32, v32, 0
    v_lshlrev_b32 v34, 16, v32
    v_and_b32 v35, 0xffff0000, v32
    v_lshlrev_b32 v36, 16, v33
    v_and_b32 v37, 0xffff0000, v33
    v_mul_f32 v34, v34, v36
    v_mul_f32 v35, v35, v37
    v_cvt_pk_bf16_f32 v30, v34, v35

    v_cvt_pk_bf16_f32 v32, v126, v127
    v_cvt_pk_bf16_f32 v33, v222, v223
    v_pk_max_i16 v32, v32, 0
    v_lshlrev_b32 v34, 16, v32
    v_and_b32 v35, 0xffff0000, v32
    v_lshlrev_b32 v36, 16, v33
    v_and_b32 v37, 0xffff0000, v33
    v_mul_f32 v34, v34, v36
    v_mul_f32 v35, v35, v37
    v_cvt_pk_bf16_f32 v31, v34, v35

    buffer_store_dwordx4 v[24:27], v10, s[16:19], s36 offen offset:2048
    buffer_store_dwordx4 v[28:31], v10, s[16:19], s36 offen offset:2064
    s_add_u32 s36, s36, 131072
    v_cvt_pk_bf16_f32 v32, v128, v129
    v_cvt_pk_bf16_f32 v33, v224, v225
    v_pk_max_i16 v32, v32, 0
    v_lshlrev_b32 v34, 16, v32
    v_and_b32 v35, 0xffff0000, v32
    v_lshlrev_b32 v36, 16, v33
    v_and_b32 v37, 0xffff0000, v33
    v_mul_f32 v34, v34, v36
    v_mul_f32 v35, v35, v37
    v_cvt_pk_bf16_f32 v16, v34, v35

    v_cvt_pk_bf16_f32 v32, v130, v131
    v_cvt_pk_bf16_f32 v33, v226, v227
    v_pk_max_i16 v32, v32, 0
    v_lshlrev_b32 v34, 16, v32
    v_and_b32 v35, 0xffff0000, v32
    v_lshlrev_b32 v36, 16, v33
    v_and_b32 v37, 0xffff0000, v33
    v_mul_f32 v34, v34, v36
    v_mul_f32 v35, v35, v37
    v_cvt_pk_bf16_f32 v17, v34, v35

    v_cvt_pk_bf16_f32 v32, v132, v133
    v_cvt_pk_bf16_f32 v33, v228, v229
    v_pk_max_i16 v32, v32, 0
    v_lshlrev_b32 v34, 16, v32
    v_and_b32 v35, 0xffff0000, v32
    v_lshlrev_b32 v36, 16, v33
    v_and_b32 v37, 0xffff0000, v33
    v_mul_f32 v34, v34, v36
    v_mul_f32 v35, v35, v37
    v_cvt_pk_bf16_f32 v18, v34, v35

    v_cvt_pk_bf16_f32 v32, v134, v135
    v_cvt_pk_bf16_f32 v33, v230, v231
    v_pk_max_i16 v32, v32, 0
    v_lshlrev_b32 v34, 16, v32
    v_and_b32 v35, 0xffff0000, v32
    v_lshlrev_b32 v36, 16, v33
    v_and_b32 v37, 0xffff0000, v33
    v_mul_f32 v34, v34, v36
    v_mul_f32 v35, v35, v37
    v_cvt_pk_bf16_f32 v19, v34, v35

    v_cvt_pk_bf16_f32 v32, v136, v137
    v_cvt_pk_bf16_f32 v33, v232, v233
    v_pk_max_i16 v32, v32, 0
    v_lshlrev_b32 v34, 16, v32
    v_and_b32 v35, 0xffff0000, v32
    v_lshlrev_b32 v36, 16, v33
    v_and_b32 v37, 0xffff0000, v33
    v_mul_f32 v34, v34, v36
    v_mul_f32 v35, v35, v37
    v_cvt_pk_bf16_f32 v20, v34, v35

    v_cvt_pk_bf16_f32 v32, v138, v139
    v_cvt_pk_bf16_f32 v33, v234, v235
    v_pk_max_i16 v32, v32, 0
    v_lshlrev_b32 v34, 16, v32
    v_and_b32 v35, 0xffff0000, v32
    v_lshlrev_b32 v36, 16, v33
    v_and_b32 v37, 0xffff0000, v33
    v_mul_f32 v34, v34, v36
    v_mul_f32 v35, v35, v37
    v_cvt_pk_bf16_f32 v21, v34, v35

    v_cvt_pk_bf16_f32 v32, v140, v141
    v_cvt_pk_bf16_f32 v33, v236, v237
    v_pk_max_i16 v32, v32, 0
    v_lshlrev_b32 v34, 16, v32
    v_and_b32 v35, 0xffff0000, v32
    v_lshlrev_b32 v36, 16, v33
    v_and_b32 v37, 0xffff0000, v33
    v_mul_f32 v34, v34, v36
    v_mul_f32 v35, v35, v37
    v_cvt_pk_bf16_f32 v22, v34, v35

    v_cvt_pk_bf16_f32 v32, v142, v143
    v_cvt_pk_bf16_f32 v33, v238, v239
    v_pk_max_i16 v32, v32, 0
    v_lshlrev_b32 v34, 16, v32
    v_and_b32 v35, 0xffff0000, v32
    v_lshlrev_b32 v36, 16, v33
    v_and_b32 v37, 0xffff0000, v33
    v_mul_f32 v34, v34, v36
    v_mul_f32 v35, v35, v37
    v_cvt_pk_bf16_f32 v23, v34, v35

    buffer_store_dwordx4 v[16:19], v10, s[16:19], s36 offen offset:0
    buffer_store_dwordx4 v[20:23], v10, s[16:19], s36 offen offset:16
    v_cvt_pk_bf16_f32 v32, v144, v145
    v_cvt_pk_bf16_f32 v33, v240, v241
    v_pk_max_i16 v32, v32, 0
    v_lshlrev_b32 v34, 16, v32
    v_and_b32 v35, 0xffff0000, v32
    v_lshlrev_b32 v36, 16, v33
    v_and_b32 v37, 0xffff0000, v33
    v_mul_f32 v34, v34, v36
    v_mul_f32 v35, v35, v37
    v_cvt_pk_bf16_f32 v24, v34, v35

    v_cvt_pk_bf16_f32 v32, v146, v147
    v_cvt_pk_bf16_f32 v33, v242, v243
    v_pk_max_i16 v32, v32, 0
    v_lshlrev_b32 v34, 16, v32
    v_and_b32 v35, 0xffff0000, v32
    v_lshlrev_b32 v36, 16, v33
    v_and_b32 v37, 0xffff0000, v33
    v_mul_f32 v34, v34, v36
    v_mul_f32 v35, v35, v37
    v_cvt_pk_bf16_f32 v25, v34, v35

    v_cvt_pk_bf16_f32 v32, v148, v149
    v_cvt_pk_bf16_f32 v33, v244, v245
    v_pk_max_i16 v32, v32, 0
    v_lshlrev_b32 v34, 16, v32
    v_and_b32 v35, 0xffff0000, v32
    v_lshlrev_b32 v36, 16, v33
    v_and_b32 v37, 0xffff0000, v33
    v_mul_f32 v34, v34, v36
    v_mul_f32 v35, v35, v37
    v_cvt_pk_bf16_f32 v26, v34, v35

    v_cvt_pk_bf16_f32 v32, v150, v151
    v_cvt_pk_bf16_f32 v33, v246, v247
    v_pk_max_i16 v32, v32, 0
    v_lshlrev_b32 v34, 16, v32
    v_and_b32 v35, 0xffff0000, v32
    v_lshlrev_b32 v36, 16, v33
    v_and_b32 v37, 0xffff0000, v33
    v_mul_f32 v34, v34, v36
    v_mul_f32 v35, v35, v37
    v_cvt_pk_bf16_f32 v27, v34, v35

    v_cvt_pk_bf16_f32 v32, v152, v153
    v_cvt_pk_bf16_f32 v33, v248, v249
    v_pk_max_i16 v32, v32, 0
    v_lshlrev_b32 v34, 16, v32
    v_and_b32 v35, 0xffff0000, v32
    v_lshlrev_b32 v36, 16, v33
    v_and_b32 v37, 0xffff0000, v33
    v_mul_f32 v34, v34, v36
    v_mul_f32 v35, v35, v37
    v_cvt_pk_bf16_f32 v28, v34, v35

    v_cvt_pk_bf16_f32 v32, v154, v155
    v_cvt_pk_bf16_f32 v33, v250, v251
    v_pk_max_i16 v32, v32, 0
    v_lshlrev_b32 v34, 16, v32
    v_and_b32 v35, 0xffff0000, v32
    v_lshlrev_b32 v36, 16, v33
    v_and_b32 v37, 0xffff0000, v33
    v_mul_f32 v34, v34, v36
    v_mul_f32 v35, v35, v37
    v_cvt_pk_bf16_f32 v29, v34, v35

    v_cvt_pk_bf16_f32 v32, v156, v157
    v_cvt_pk_bf16_f32 v33, v252, v253
    v_pk_max_i16 v32, v32, 0
    v_lshlrev_b32 v34, 16, v32
    v_and_b32 v35, 0xffff0000, v32
    v_lshlrev_b32 v36, 16, v33
    v_and_b32 v37, 0xffff0000, v33
    v_mul_f32 v34, v34, v36
    v_mul_f32 v35, v35, v37
    v_cvt_pk_bf16_f32 v30, v34, v35

    v_cvt_pk_bf16_f32 v32, v158, v159
    v_cvt_pk_bf16_f32 v33, v254, v255
    v_pk_max_i16 v32, v32, 0
    v_lshlrev_b32 v34, 16, v32
    v_and_b32 v35, 0xffff0000, v32
    v_lshlrev_b32 v36, 16, v33
    v_and_b32 v37, 0xffff0000, v33
    v_mul_f32 v34, v34, v36
    v_mul_f32 v35, v35, v37
    v_cvt_pk_bf16_f32 v31, v34, v35

    buffer_store_dwordx4 v[24:27], v10, s[16:19], s36 offen offset:2048
    buffer_store_dwordx4 v[28:31], v10, s[16:19], s36 offen offset:2064
    s_add_u32 s36, s36, 131072
    s_waitcnt vmcnt(0)
    s_endpgm
QKV_ROLE:
    s_sub_u32 s20, s2, 192
    s_and_b32 s21, s20, 3
    s_lshr_b32 s22, s20, 3
    s_lshl_b32 s22, s22, 1
    s_lshr_b32 s23, s20, 2
    s_and_b32 s23, s23, 1
    s_add_u32 s20, s22, s23
    s_lshr_b32 s22, s3, 2
    s_and_b32 s23, s3, 3

    s_mul_i32 s36, s21, 497664
    s_add_u32 s24, s4, 0x3000000
    s_addc_u32 s25, s5, 0
    s_add_u32 s24, s24, s36
    s_addc_u32 s25, s25, 0
    s_mov_b32 s26, 497664
    s_mov_b32 s27, 0x00020000
    s_lshl_b32 s36, s3, 10
    s_add_u32 s36, s36, 0
    v_lshlrev_b32 v2, 4, v0
    v_add_u32 v2, s36, v2
    s_lshl_b32 s36, s3, 10
    s_add_u32 s36, s36, 8192
    v_lshlrev_b32 v3, 4, v0
    v_add_u32 v3, s36, v3
    s_lshl_b32 s36, s3, 10
    s_add_u32 s36, s36, 16384
    v_lshlrev_b32 v4, 4, v0
    v_add_u32 v4, s36, v4
    s_lshl_b32 s36, s3, 10
    s_add_u32 s36, s36, 24576
    v_lshlrev_b32 v5, 4, v0
    v_add_u32 v5, s36, v5
    v_lshrrev_b32 v10, 2, v0
    v_and_b32 v11, 3, v0
    v_lshrrev_b32 v12, 4, v0
    v_sub_u32 v12, 4, v12
    v_and_b32 v12, 3, v12
    v_xor_b32 v11, v11, v12
    v_lshlrev_b32 v6, 6, v10
    v_lshl_add_u32 v6, v11, 4, v6

    s_mov_b32 s44, 0
    s_lshl_b32 s36, s20, 7
    s_sub_u32 s37, s3, 3
    s_lshl_b32 s37, s37, 5
    s_add_u32 s36, s36, s37
    s_sub_u32 s36, s36, 16
    s_max_i32 s38, s36, 0
    s_lshl_b32 s38, s38, 6
    s_add_u32 s39, s36, 16
    s_lshl_b32 s39, s39, 6
    s_cmp_lt_u32 s3, 3
    s_cselect_b32 s28, s24, s12
    s_cselect_b32 s29, s25, s13
    s_cselect_b32 s30, s26, s14
    s_mov_b32 s31, 0x00020000
    s_cselect_b32 s45, s44, s38
    s_cselect_b32 s46, 0x7f000000, s39
    s_mov_b32 s47, 131072
    s_cselect_b32 s47, 27648, s47
    s_lshl_b32 s48, s3, 10
    s_add_u32 s48, s48, 10240
    s_add_u32 s37, s48, 24576
    s_sub_u32 s36, s3, 3
    s_lshl_b32 s36, s36, 11
    s_add_u32 s50, s36, 1024
    s_cmp_lt_u32 s3, 3
    s_cselect_b32 s49, s37, s36

    s_cmp_lt_u32 s3, 3
    s_cselect_b32 s51, 1, 0
    v_mov_b32 v7, v6
    s_cmp_lt_u32 s3, 3
    s_cbranch_scc0 QK_S3TOK
    v_mov_b32 v7, v5

QK_S3TOK:
    s_mov_b32 s32, 0
    s_add_u32 m0, s32, s48
    s_nop 0
    buffer_load_dwordx4 v2, s[24:27], s44 offen lds
    s_add_u32 m0, m0, 8192
    s_nop 0
    buffer_load_dwordx4 v3, s[24:27], s44 offen lds
    s_add_u32 m0, m0, 8192
    s_nop 0
    buffer_load_dwordx4 v4, s[24:27], s44 offen lds
    s_add_u32 m0, s32, s49
    s_add_u32 s44, s44, 27648
    buffer_load_dwordx4 v7, s[28:31], s45 offen lds
    s_add_u32 m0, s32, s50
    s_cmp_eq_u32 s51, 1
    s_cselect_b32 m0, 151552, m0
    s_add_u32 s45, s45, s47
    buffer_load_dwordx4 v6, s[12:15], s46 offen lds
    s_add_u32 s46, s46, 131072
    v_and_b32 v10, 15, v0
    v_lshrrev_b32 v11, 2, v10
    v_sub_u32 v11, 4, v11
    v_and_b32 v11, 3, v11
    v_lshrrev_b32 v12, 4, v0
    v_xor_b32 v11, v11, v12
    s_mul_i32 s36, s22, 80
    v_add_u32 v10, s36, v10
    v_lshlrev_b32 v8, 6, v10
    v_lshl_add_u32 v8, v11, 4, v8
    v_lshrrev_b32 v13, 2, v0
    v_and_b32 v13, 3, v13
    v_lshl_add_u32 v13, v12, 2, v13
    v_mul_u32_u24 v9, 864, v13
    v_and_b32 v14, 3, v0
    v_lshl_add_u32 v9, v14, 3, v9
    s_mul_i32 s36, s23, 224
    s_add_u32 s36, s36, 10240
    v_add_u32 v9, s36, v9

    v_mov_b32 v100, 0
    v_mov_b32 v101, 0
    v_mov_b32 v102, 0
    v_mov_b32 v103, 0
    v_mov_b32 v104, 0
    v_mov_b32 v105, 0
    v_mov_b32 v106, 0
    v_mov_b32 v107, 0
    v_mov_b32 v108, 0
    v_mov_b32 v109, 0
    v_mov_b32 v110, 0
    v_mov_b32 v111, 0
    v_mov_b32 v112, 0
    v_mov_b32 v113, 0
    v_mov_b32 v114, 0
    v_mov_b32 v115, 0
    v_mov_b32 v116, 0
    v_mov_b32 v117, 0
    v_mov_b32 v118, 0
    v_mov_b32 v119, 0
    v_mov_b32 v120, 0
    v_mov_b32 v121, 0
    v_mov_b32 v122, 0
    v_mov_b32 v123, 0
    v_mov_b32 v124, 0
    v_mov_b32 v125, 0
    v_mov_b32 v126, 0
    v_mov_b32 v127, 0
    v_mov_b32 v128, 0
    v_mov_b32 v129, 0
    v_mov_b32 v130, 0
    v_mov_b32 v131, 0
    v_mov_b32 v132, 0
    v_mov_b32 v133, 0
    v_mov_b32 v134, 0
    v_mov_b32 v135, 0
    v_mov_b32 v136, 0
    v_mov_b32 v137, 0
    v_mov_b32 v138, 0
    v_mov_b32 v139, 0
    v_mov_b32 v140, 0
    v_mov_b32 v141, 0
    v_mov_b32 v142, 0
    v_mov_b32 v143, 0
    v_mov_b32 v144, 0
    v_mov_b32 v145, 0
    v_mov_b32 v146, 0
    v_mov_b32 v147, 0
    v_mov_b32 v148, 0
    v_mov_b32 v149, 0
    v_mov_b32 v150, 0
    v_mov_b32 v151, 0
    v_mov_b32 v152, 0
    v_mov_b32 v153, 0
    v_mov_b32 v154, 0
    v_mov_b32 v155, 0
    v_mov_b32 v156, 0
    v_mov_b32 v157, 0
    v_mov_b32 v158, 0
    v_mov_b32 v159, 0
    v_mov_b32 v160, 0
    v_mov_b32 v161, 0
    v_mov_b32 v162, 0
    v_mov_b32 v163, 0
    v_mov_b32 v164, 0
    v_mov_b32 v165, 0
    v_mov_b32 v166, 0
    v_mov_b32 v167, 0
    v_mov_b32 v168, 0
    v_mov_b32 v169, 0
    v_mov_b32 v170, 0
    v_mov_b32 v171, 0
    v_mov_b32 v172, 0
    v_mov_b32 v173, 0
    v_mov_b32 v174, 0
    v_mov_b32 v175, 0
    v_mov_b32 v176, 0
    v_mov_b32 v177, 0
    v_mov_b32 v178, 0
    v_mov_b32 v179, 0
    v_mov_b32 v180, 0
    v_mov_b32 v181, 0
    v_mov_b32 v182, 0
    v_mov_b32 v183, 0
    v_mov_b32 v184, 0
    v_mov_b32 v185, 0
    v_mov_b32 v186, 0
    v_mov_b32 v187, 0
    v_mov_b32 v188, 0
    v_mov_b32 v189, 0
    v_mov_b32 v190, 0
    v_mov_b32 v191, 0
    v_mov_b32 v192, 0
    v_mov_b32 v193, 0
    v_mov_b32 v194, 0
    v_mov_b32 v195, 0
    v_mov_b32 v196, 0
    v_mov_b32 v197, 0
    v_mov_b32 v198, 0
    v_mov_b32 v199, 0
    v_mov_b32 v200, 0
    v_mov_b32 v201, 0
    v_mov_b32 v202, 0
    v_mov_b32 v203, 0
    v_mov_b32 v204, 0
    v_mov_b32 v205, 0
    v_mov_b32 v206, 0
    v_mov_b32 v207, 0
    v_mov_b32 v208, 0
    v_mov_b32 v209, 0
    v_mov_b32 v210, 0
    v_mov_b32 v211, 0
    v_mov_b32 v212, 0
    v_mov_b32 v213, 0
    v_mov_b32 v214, 0
    v_mov_b32 v215, 0
    v_mov_b32 v216, 0
    v_mov_b32 v217, 0
    v_mov_b32 v218, 0
    v_mov_b32 v219, 0
    v_mov_b32 v220, 0
    v_mov_b32 v221, 0
    v_mov_b32 v222, 0
    v_mov_b32 v223, 0
    v_mov_b32 v224, 0
    v_mov_b32 v225, 0
    v_mov_b32 v226, 0
    v_mov_b32 v227, 0
    v_mov_b32 v228, 0
    v_mov_b32 v229, 0
    v_mov_b32 v230, 0
    v_mov_b32 v231, 0
    v_mov_b32 v232, 0
    v_mov_b32 v233, 0
    v_mov_b32 v234, 0
    v_mov_b32 v235, 0
    v_mov_b32 v236, 0
    v_mov_b32 v237, 0
    v_mov_b32 v238, 0
    v_mov_b32 v239, 0
    v_and_b32 v10, 15, v0
    s_mul_i32 s36, s22, 80
    v_add_u32 v10, s36, v10
    v_mul_u32_u24 v10, 1000, v10
    v_lshrrev_b32 v11, 4, v0
    v_lshlrev_b32 v11, 2, v11
    s_mul_i32 s36, s23, 112
    v_add_u32 v11, s36, v11

    v_add_u32 v12, 0, v11
    v_mul_u32_u24 v13, 456, v12
    v_lshrrev_b32 v13, 16, v13
    v_mul_u32_u24 v14, 144, v13
    v_sub_u32 v12, v12, v14
    v_mul_u32_u24 v14, 3641, v12
    v_lshrrev_b32 v14, 16, v14
    v_mul_u32_u24 v15, 18, v14
    v_sub_u32 v12, v12, v15
    v_mul_u32_u24 v13, 320, v13
    v_mul_u32_u24 v14, 40, v14
    v_add3_u32 v13, v13, v14, v10
    v_lshl_add_u32 v84, v12, 1, v13

    v_add_u32 v12, 2, v11
    v_mul_u32_u24 v13, 456, v12
    v_lshrrev_b32 v13, 16, v13
    v_mul_u32_u24 v14, 144, v13
    v_sub_u32 v12, v12, v14
    v_mul_u32_u24 v14, 3641, v12
    v_lshrrev_b32 v14, 16, v14
    v_mul_u32_u24 v15, 18, v14
    v_sub_u32 v12, v12, v15
    v_mul_u32_u24 v13, 320, v13
    v_mul_u32_u24 v14, 40, v14
    v_add3_u32 v13, v13, v14, v10
    v_lshl_add_u32 v85, v12, 1, v13

    v_add_u32 v12, 16, v11
    v_mul_u32_u24 v13, 456, v12
    v_lshrrev_b32 v13, 16, v13
    v_mul_u32_u24 v14, 144, v13
    v_sub_u32 v12, v12, v14
    v_mul_u32_u24 v14, 3641, v12
    v_lshrrev_b32 v14, 16, v14
    v_mul_u32_u24 v15, 18, v14
    v_sub_u32 v12, v12, v15
    v_mul_u32_u24 v13, 320, v13
    v_mul_u32_u24 v14, 40, v14
    v_add3_u32 v13, v13, v14, v10
    v_lshl_add_u32 v86, v12, 1, v13

    v_add_u32 v12, 18, v11
    v_mul_u32_u24 v13, 456, v12
    v_lshrrev_b32 v13, 16, v13
    v_mul_u32_u24 v14, 144, v13
    v_sub_u32 v12, v12, v14
    v_mul_u32_u24 v14, 3641, v12
    v_lshrrev_b32 v14, 16, v14
    v_mul_u32_u24 v15, 18, v14
    v_sub_u32 v12, v12, v15
    v_mul_u32_u24 v13, 320, v13
    v_mul_u32_u24 v14, 40, v14
    v_add3_u32 v13, v13, v14, v10
    v_lshl_add_u32 v87, v12, 1, v13

    v_add_u32 v12, 32, v11
    v_mul_u32_u24 v13, 456, v12
    v_lshrrev_b32 v13, 16, v13
    v_mul_u32_u24 v14, 144, v13
    v_sub_u32 v12, v12, v14
    v_mul_u32_u24 v14, 3641, v12
    v_lshrrev_b32 v14, 16, v14
    v_mul_u32_u24 v15, 18, v14
    v_sub_u32 v12, v12, v15
    v_mul_u32_u24 v13, 320, v13
    v_mul_u32_u24 v14, 40, v14
    v_add3_u32 v13, v13, v14, v10
    v_lshl_add_u32 v88, v12, 1, v13

    v_add_u32 v12, 34, v11
    v_mul_u32_u24 v13, 456, v12
    v_lshrrev_b32 v13, 16, v13
    v_mul_u32_u24 v14, 144, v13
    v_sub_u32 v12, v12, v14
    v_mul_u32_u24 v14, 3641, v12
    v_lshrrev_b32 v14, 16, v14
    v_mul_u32_u24 v15, 18, v14
    v_sub_u32 v12, v12, v15
    v_mul_u32_u24 v13, 320, v13
    v_mul_u32_u24 v14, 40, v14
    v_add3_u32 v13, v13, v14, v10
    v_lshl_add_u32 v89, v12, 1, v13

    v_add_u32 v12, 48, v11
    v_mul_u32_u24 v13, 456, v12
    v_lshrrev_b32 v13, 16, v13
    v_mul_u32_u24 v14, 144, v13
    v_sub_u32 v12, v12, v14
    v_mul_u32_u24 v14, 3641, v12
    v_lshrrev_b32 v14, 16, v14
    v_mul_u32_u24 v15, 18, v14
    v_sub_u32 v12, v12, v15
    v_mul_u32_u24 v13, 320, v13
    v_mul_u32_u24 v14, 40, v14
    v_add3_u32 v13, v13, v14, v10
    v_lshl_add_u32 v90, v12, 1, v13

    v_add_u32 v12, 50, v11
    v_mul_u32_u24 v13, 456, v12
    v_lshrrev_b32 v13, 16, v13
    v_mul_u32_u24 v14, 144, v13
    v_sub_u32 v12, v12, v14
    v_mul_u32_u24 v14, 3641, v12
    v_lshrrev_b32 v14, 16, v14
    v_mul_u32_u24 v15, 18, v14
    v_sub_u32 v12, v12, v15
    v_mul_u32_u24 v13, 320, v13
    v_mul_u32_u24 v14, 40, v14
    v_add3_u32 v13, v13, v14, v10
    v_lshl_add_u32 v91, v12, 1, v13

    v_add_u32 v12, 64, v11
    v_mul_u32_u24 v13, 456, v12
    v_lshrrev_b32 v13, 16, v13
    v_mul_u32_u24 v14, 144, v13
    v_sub_u32 v12, v12, v14
    v_mul_u32_u24 v14, 3641, v12
    v_lshrrev_b32 v14, 16, v14
    v_mul_u32_u24 v15, 18, v14
    v_sub_u32 v12, v12, v15
    v_mul_u32_u24 v13, 320, v13
    v_mul_u32_u24 v14, 40, v14
    v_add3_u32 v13, v13, v14, v10
    v_lshl_add_u32 v92, v12, 1, v13

    v_add_u32 v12, 66, v11
    v_mul_u32_u24 v13, 456, v12
    v_lshrrev_b32 v13, 16, v13
    v_mul_u32_u24 v14, 144, v13
    v_sub_u32 v12, v12, v14
    v_mul_u32_u24 v14, 3641, v12
    v_lshrrev_b32 v14, 16, v14
    v_mul_u32_u24 v15, 18, v14
    v_sub_u32 v12, v12, v15
    v_mul_u32_u24 v13, 320, v13
    v_mul_u32_u24 v14, 40, v14
    v_add3_u32 v13, v13, v14, v10
    v_lshl_add_u32 v93, v12, 1, v13

    v_add_u32 v12, 80, v11
    v_mul_u32_u24 v13, 456, v12
    v_lshrrev_b32 v13, 16, v13
    v_mul_u32_u24 v14, 144, v13
    v_sub_u32 v12, v12, v14
    v_mul_u32_u24 v14, 3641, v12
    v_lshrrev_b32 v14, 16, v14
    v_mul_u32_u24 v15, 18, v14
    v_sub_u32 v12, v12, v15
    v_mul_u32_u24 v13, 320, v13
    v_mul_u32_u24 v14, 40, v14
    v_add3_u32 v13, v13, v14, v10
    v_lshl_add_u32 v94, v12, 1, v13

    v_add_u32 v12, 82, v11
    v_mul_u32_u24 v13, 456, v12
    v_lshrrev_b32 v13, 16, v13
    v_mul_u32_u24 v14, 144, v13
    v_sub_u32 v12, v12, v14
    v_mul_u32_u24 v14, 3641, v12
    v_lshrrev_b32 v14, 16, v14
    v_mul_u32_u24 v15, 18, v14
    v_sub_u32 v12, v12, v15
    v_mul_u32_u24 v13, 320, v13
    v_mul_u32_u24 v14, 40, v14
    v_add3_u32 v13, v13, v14, v10
    v_lshl_add_u32 v95, v12, 1, v13

    v_add_u32 v12, 96, v11
    v_mul_u32_u24 v13, 456, v12
    v_lshrrev_b32 v13, 16, v13
    v_mul_u32_u24 v14, 144, v13
    v_sub_u32 v12, v12, v14
    v_mul_u32_u24 v14, 3641, v12
    v_lshrrev_b32 v14, 16, v14
    v_mul_u32_u24 v15, 18, v14
    v_sub_u32 v12, v12, v15
    v_mul_u32_u24 v13, 320, v13
    v_mul_u32_u24 v14, 40, v14
    v_add3_u32 v13, v13, v14, v10
    v_lshl_add_u32 v96, v12, 1, v13

    v_add_u32 v12, 98, v11
    v_mul_u32_u24 v13, 456, v12
    v_lshrrev_b32 v13, 16, v13
    v_mul_u32_u24 v14, 144, v13
    v_sub_u32 v12, v12, v14
    v_mul_u32_u24 v14, 3641, v12
    v_lshrrev_b32 v14, 16, v14
    v_mul_u32_u24 v15, 18, v14
    v_sub_u32 v12, v12, v15
    v_mul_u32_u24 v13, 320, v13
    v_mul_u32_u24 v14, 40, v14
    v_add3_u32 v13, v13, v14, v10
    v_lshl_add_u32 v97, v12, 1, v13

    s_mov_b32 s32, 37888
    s_add_u32 m0, s32, s48
    s_nop 0
    buffer_load_dwordx4 v2, s[24:27], s44 offen lds
    s_add_u32 m0, m0, 8192
    s_nop 0
    buffer_load_dwordx4 v3, s[24:27], s44 offen lds
    s_add_u32 m0, m0, 8192
    s_nop 0
    buffer_load_dwordx4 v4, s[24:27], s44 offen lds
    s_add_u32 m0, s32, s49
    s_add_u32 s44, s44, 27648
    buffer_load_dwordx4 v7, s[28:31], s45 offen lds
    s_add_u32 m0, s32, s50
    s_cmp_eq_u32 s51, 1
    s_cselect_b32 m0, 151552, m0
    s_add_u32 s45, s45, s47
    buffer_load_dwordx4 v6, s[12:15], s46 offen lds
    s_add_u32 s46, s46, 131072
    s_mov_b32 s32, 75776
    s_add_u32 m0, s32, s48
    s_nop 0
    buffer_load_dwordx4 v2, s[24:27], s44 offen lds
    s_add_u32 m0, m0, 8192
    s_nop 0
    buffer_load_dwordx4 v3, s[24:27], s44 offen lds
    s_add_u32 m0, m0, 8192
    s_nop 0
    buffer_load_dwordx4 v4, s[24:27], s44 offen lds
    s_add_u32 m0, s32, s49
    s_add_u32 s44, s44, 27648
    buffer_load_dwordx4 v7, s[28:31], s45 offen lds
    s_add_u32 m0, s32, s50
    s_cmp_eq_u32 s51, 1
    s_cselect_b32 m0, 151552, m0
    s_add_u32 s45, s45, s47
    buffer_load_dwordx4 v6, s[12:15], s46 offen lds
    s_add_u32 s46, s46, 131072
    s_mov_b32 s32, 113664
    s_mov_b32 s33, 0
    s_waitcnt vmcnt(10)
    s_barrier
    v_add_u32 v10, s33, v8
    v_add_u32 v12, s33, v9
    ds_read_b128 v[16:19], v10 offset:0
    ds_read_b128 v[20:23], v10 offset:1024
    ds_read_b128 v[24:27], v10 offset:2048
    ds_read_b128 v[28:31], v10 offset:3072
    ds_read_b128 v[32:35], v10 offset:4096
    ds_read_b64_tr_b16 v[56:57], v12 offset:0
    ds_read_b64_tr_b16 v[58:59], v12 offset:13824
    ds_read_b64_tr_b16 v[60:61], v12 offset:32
    ds_read_b64_tr_b16 v[62:63], v12 offset:13856
    ds_read_b64_tr_b16 v[64:65], v12 offset:64
    ds_read_b64_tr_b16 v[66:67], v12 offset:13888
    s_mov_b32 s34, 0
QK_LOOP:
    s_waitcnt vmcnt(5)
    s_barrier
    s_add_u32 s33, s33, 37888
    s_cmp_eq_u32 s33, 151552
    s_cselect_b32 s33, 0, s33
    v_mov_b32 v11, v12
    v_add_u32 v10, s33, v8
    v_add_u32 v12, s33, v9

    s_waitcnt lgkmcnt(4)
    v_mfma_f32_16x16x32_bf16 v[100:103], v[56:59], v[16:19], v[100:103]
    v_mfma_f32_16x16x32_bf16 v[104:107], v[56:59], v[20:23], v[104:107]
    v_mfma_f32_16x16x32_bf16 v[108:111], v[56:59], v[24:27], v[108:111]
    v_mfma_f32_16x16x32_bf16 v[112:115], v[56:59], v[28:31], v[112:115]
    s_cmp_eq_u32 s22, 1
    s_cbranch_scc1 QK_SK1
    v_mfma_f32_16x16x32_bf16 v[116:119], v[56:59], v[32:35], v[116:119]
QK_SK1:
    ds_read_b128 v[36:39], v10 offset:0
    ds_read_b64_tr_b16 v[68:69], v11 offset:96
    ds_read_b64_tr_b16 v[70:71], v11 offset:13920
    s_add_u32 m0, s32, s48
    s_nop 0
    buffer_load_dwordx4 v2, s[24:27], s44 offen lds
    s_waitcnt lgkmcnt(5)
    v_mfma_f32_16x16x32_bf16 v[120:123], v[60:63], v[16:19], v[120:123]
    v_mfma_f32_16x16x32_bf16 v[124:127], v[60:63], v[20:23], v[124:127]
    v_mfma_f32_16x16x32_bf16 v[128:131], v[60:63], v[24:27], v[128:131]
    v_mfma_f32_16x16x32_bf16 v[132:135], v[60:63], v[28:31], v[132:135]
    s_cmp_eq_u32 s22, 1
    s_cbranch_scc1 QK_SK2
    v_mfma_f32_16x16x32_bf16 v[136:139], v[60:63], v[32:35], v[136:139]
QK_SK2:
    ds_read_b128 v[40:43], v10 offset:1024
    ds_read_b64_tr_b16 v[72:73], v11 offset:128
    ds_read_b64_tr_b16 v[74:75], v11 offset:13952
    s_add_u32 m0, m0, 8192
    s_nop 0
    buffer_load_dwordx4 v3, s[24:27], s44 offen lds
    s_waitcnt lgkmcnt(6)
    v_mfma_f32_16x16x32_bf16 v[140:143], v[64:67], v[16:19], v[140:143]
    v_mfma_f32_16x16x32_bf16 v[144:147], v[64:67], v[20:23], v[144:147]
    v_mfma_f32_16x16x32_bf16 v[148:151], v[64:67], v[24:27], v[148:151]
    v_mfma_f32_16x16x32_bf16 v[152:155], v[64:67], v[28:31], v[152:155]
    s_cmp_eq_u32 s22, 1
    s_cbranch_scc1 QK_SK3
    v_mfma_f32_16x16x32_bf16 v[156:159], v[64:67], v[32:35], v[156:159]
QK_SK3:
    ds_read_b128 v[44:47], v10 offset:2048
    ds_read_b64_tr_b16 v[76:77], v11 offset:160
    ds_read_b64_tr_b16 v[78:79], v11 offset:13984
    s_add_u32 m0, m0, 8192
    s_nop 0
    buffer_load_dwordx4 v4, s[24:27], s44 offen lds
    s_waitcnt lgkmcnt(6)
    v_mfma_f32_16x16x32_bf16 v[160:163], v[68:71], v[16:19], v[160:163]
    v_mfma_f32_16x16x32_bf16 v[164:167], v[68:71], v[20:23], v[164:167]
    v_mfma_f32_16x16x32_bf16 v[168:171], v[68:71], v[24:27], v[168:171]
    v_mfma_f32_16x16x32_bf16 v[172:175], v[68:71], v[28:31], v[172:175]
    s_cmp_eq_u32 s22, 1
    s_cbranch_scc1 QK_SK4
    v_mfma_f32_16x16x32_bf16 v[176:179], v[68:71], v[32:35], v[176:179]
QK_SK4:
    ds_read_b128 v[48:51], v10 offset:3072
    ds_read_b64_tr_b16 v[80:81], v11 offset:192
    ds_read_b64_tr_b16 v[82:83], v11 offset:14016
    s_add_u32 m0, s32, s49
    s_add_u32 s44, s44, 27648
    buffer_load_dwordx4 v7, s[28:31], s45 offen lds
    s_waitcnt lgkmcnt(6)
    v_mfma_f32_16x16x32_bf16 v[180:183], v[72:75], v[16:19], v[180:183]
    v_mfma_f32_16x16x32_bf16 v[184:187], v[72:75], v[20:23], v[184:187]
    v_mfma_f32_16x16x32_bf16 v[188:191], v[72:75], v[24:27], v[188:191]
    v_mfma_f32_16x16x32_bf16 v[192:195], v[72:75], v[28:31], v[192:195]
    s_cmp_eq_u32 s22, 1
    s_cbranch_scc1 QK_SK5
    v_mfma_f32_16x16x32_bf16 v[196:199], v[72:75], v[32:35], v[196:199]
QK_SK5:
    ds_read_b128 v[52:55], v10 offset:4096
    ds_read_b64_tr_b16 v[56:57], v12 offset:0
    ds_read_b64_tr_b16 v[58:59], v12 offset:13824
    s_add_u32 m0, s32, s50
    s_cmp_eq_u32 s51, 1
    s_cselect_b32 m0, 151552, m0
    s_add_u32 s45, s45, s47
    buffer_load_dwordx4 v6, s[12:15], s46 offen lds
    s_add_u32 s46, s46, 131072
    s_waitcnt lgkmcnt(6)
    v_mfma_f32_16x16x32_bf16 v[200:203], v[76:79], v[16:19], v[200:203]
    v_mfma_f32_16x16x32_bf16 v[204:207], v[76:79], v[20:23], v[204:207]
    v_mfma_f32_16x16x32_bf16 v[208:211], v[76:79], v[24:27], v[208:211]
    v_mfma_f32_16x16x32_bf16 v[212:215], v[76:79], v[28:31], v[212:215]
    s_cmp_eq_u32 s22, 1
    s_cbranch_scc1 QK_SK6
    v_mfma_f32_16x16x32_bf16 v[216:219], v[76:79], v[32:35], v[216:219]
QK_SK6:
    ds_read_b64_tr_b16 v[60:61], v12 offset:32
    ds_read_b64_tr_b16 v[62:63], v12 offset:13856
    s_waitcnt lgkmcnt(5)
    v_mfma_f32_16x16x32_bf16 v[220:223], v[80:83], v[16:19], v[220:223]
    v_mfma_f32_16x16x32_bf16 v[224:227], v[80:83], v[20:23], v[224:227]
    v_mfma_f32_16x16x32_bf16 v[228:231], v[80:83], v[24:27], v[228:231]
    v_mfma_f32_16x16x32_bf16 v[232:235], v[80:83], v[28:31], v[232:235]
    s_cmp_eq_u32 s22, 1
    s_cbranch_scc1 QK_SK7
    v_mfma_f32_16x16x32_bf16 v[236:239], v[80:83], v[32:35], v[236:239]
QK_SK7:
    ds_read_b64_tr_b16 v[64:65], v12 offset:64
    ds_read_b64_tr_b16 v[66:67], v12 offset:13888
    s_add_u32 s32, s32, 37888
    s_cmp_eq_u32 s32, 151552
    s_cselect_b32 s32, 0, s32

    s_waitcnt vmcnt(5)
    s_barrier
    s_add_u32 s33, s33, 37888
    s_cmp_eq_u32 s33, 151552
    s_cselect_b32 s33, 0, s33
    v_mov_b32 v11, v12
    v_add_u32 v10, s33, v8
    v_add_u32 v12, s33, v9

    s_waitcnt lgkmcnt(4)
    v_mfma_f32_16x16x32_bf16 v[100:103], v[56:59], v[36:39], v[100:103]
    v_mfma_f32_16x16x32_bf16 v[104:107], v[56:59], v[40:43], v[104:107]
    v_mfma_f32_16x16x32_bf16 v[108:111], v[56:59], v[44:47], v[108:111]
    v_mfma_f32_16x16x32_bf16 v[112:115], v[56:59], v[48:51], v[112:115]
    s_cmp_eq_u32 s22, 1
    s_cbranch_scc1 QK_SK8
    v_mfma_f32_16x16x32_bf16 v[116:119], v[56:59], v[52:55], v[116:119]
QK_SK8:
    ds_read_b128 v[16:19], v10 offset:0
    ds_read_b64_tr_b16 v[68:69], v11 offset:96
    ds_read_b64_tr_b16 v[70:71], v11 offset:13920
    s_add_u32 m0, s32, s48
    s_nop 0
    buffer_load_dwordx4 v2, s[24:27], s44 offen lds
    s_waitcnt lgkmcnt(5)
    v_mfma_f32_16x16x32_bf16 v[120:123], v[60:63], v[36:39], v[120:123]
    v_mfma_f32_16x16x32_bf16 v[124:127], v[60:63], v[40:43], v[124:127]
    v_mfma_f32_16x16x32_bf16 v[128:131], v[60:63], v[44:47], v[128:131]
    v_mfma_f32_16x16x32_bf16 v[132:135], v[60:63], v[48:51], v[132:135]
    s_cmp_eq_u32 s22, 1
    s_cbranch_scc1 QK_SK9
    v_mfma_f32_16x16x32_bf16 v[136:139], v[60:63], v[52:55], v[136:139]
QK_SK9:
    ds_read_b128 v[20:23], v10 offset:1024
    ds_read_b64_tr_b16 v[72:73], v11 offset:128
    ds_read_b64_tr_b16 v[74:75], v11 offset:13952
    s_add_u32 m0, m0, 8192
    s_nop 0
    buffer_load_dwordx4 v3, s[24:27], s44 offen lds
    s_waitcnt lgkmcnt(6)
    v_mfma_f32_16x16x32_bf16 v[140:143], v[64:67], v[36:39], v[140:143]
    v_mfma_f32_16x16x32_bf16 v[144:147], v[64:67], v[40:43], v[144:147]
    v_mfma_f32_16x16x32_bf16 v[148:151], v[64:67], v[44:47], v[148:151]
    v_mfma_f32_16x16x32_bf16 v[152:155], v[64:67], v[48:51], v[152:155]
    s_cmp_eq_u32 s22, 1
    s_cbranch_scc1 QK_SK10
    v_mfma_f32_16x16x32_bf16 v[156:159], v[64:67], v[52:55], v[156:159]
QK_SK10:
    ds_read_b128 v[24:27], v10 offset:2048
    ds_read_b64_tr_b16 v[76:77], v11 offset:160
    ds_read_b64_tr_b16 v[78:79], v11 offset:13984
    s_add_u32 m0, m0, 8192
    s_nop 0
    buffer_load_dwordx4 v4, s[24:27], s44 offen lds
    s_waitcnt lgkmcnt(6)
    v_mfma_f32_16x16x32_bf16 v[160:163], v[68:71], v[36:39], v[160:163]
    v_mfma_f32_16x16x32_bf16 v[164:167], v[68:71], v[40:43], v[164:167]
    v_mfma_f32_16x16x32_bf16 v[168:171], v[68:71], v[44:47], v[168:171]
    v_mfma_f32_16x16x32_bf16 v[172:175], v[68:71], v[48:51], v[172:175]
    s_cmp_eq_u32 s22, 1
    s_cbranch_scc1 QK_SK11
    v_mfma_f32_16x16x32_bf16 v[176:179], v[68:71], v[52:55], v[176:179]
QK_SK11:
    ds_read_b128 v[28:31], v10 offset:3072
    ds_read_b64_tr_b16 v[80:81], v11 offset:192
    ds_read_b64_tr_b16 v[82:83], v11 offset:14016
    s_add_u32 m0, s32, s49
    s_add_u32 s44, s44, 27648
    buffer_load_dwordx4 v7, s[28:31], s45 offen lds
    s_waitcnt lgkmcnt(6)
    v_mfma_f32_16x16x32_bf16 v[180:183], v[72:75], v[36:39], v[180:183]
    v_mfma_f32_16x16x32_bf16 v[184:187], v[72:75], v[40:43], v[184:187]
    v_mfma_f32_16x16x32_bf16 v[188:191], v[72:75], v[44:47], v[188:191]
    v_mfma_f32_16x16x32_bf16 v[192:195], v[72:75], v[48:51], v[192:195]
    s_cmp_eq_u32 s22, 1
    s_cbranch_scc1 QK_SK12
    v_mfma_f32_16x16x32_bf16 v[196:199], v[72:75], v[52:55], v[196:199]
QK_SK12:
    ds_read_b128 v[32:35], v10 offset:4096
    ds_read_b64_tr_b16 v[56:57], v12 offset:0
    ds_read_b64_tr_b16 v[58:59], v12 offset:13824
    s_add_u32 m0, s32, s50
    s_cmp_eq_u32 s51, 1
    s_cselect_b32 m0, 151552, m0
    s_add_u32 s45, s45, s47
    buffer_load_dwordx4 v6, s[12:15], s46 offen lds
    s_add_u32 s46, s46, 131072
    s_waitcnt lgkmcnt(6)
    v_mfma_f32_16x16x32_bf16 v[200:203], v[76:79], v[36:39], v[200:203]
    v_mfma_f32_16x16x32_bf16 v[204:207], v[76:79], v[40:43], v[204:207]
    v_mfma_f32_16x16x32_bf16 v[208:211], v[76:79], v[44:47], v[208:211]
    v_mfma_f32_16x16x32_bf16 v[212:215], v[76:79], v[48:51], v[212:215]
    s_cmp_eq_u32 s22, 1
    s_cbranch_scc1 QK_SK13
    v_mfma_f32_16x16x32_bf16 v[216:219], v[76:79], v[52:55], v[216:219]
QK_SK13:
    ds_read_b64_tr_b16 v[60:61], v12 offset:32
    ds_read_b64_tr_b16 v[62:63], v12 offset:13856
    s_waitcnt lgkmcnt(5)
    v_mfma_f32_16x16x32_bf16 v[220:223], v[80:83], v[36:39], v[220:223]
    v_mfma_f32_16x16x32_bf16 v[224:227], v[80:83], v[40:43], v[224:227]
    v_mfma_f32_16x16x32_bf16 v[228:231], v[80:83], v[44:47], v[228:231]
    v_mfma_f32_16x16x32_bf16 v[232:235], v[80:83], v[48:51], v[232:235]
    s_cmp_eq_u32 s22, 1
    s_cbranch_scc1 QK_SK14
    v_mfma_f32_16x16x32_bf16 v[236:239], v[80:83], v[52:55], v[236:239]
QK_SK14:
    ds_read_b64_tr_b16 v[64:65], v12 offset:64
    ds_read_b64_tr_b16 v[66:67], v12 offset:13888
    s_add_u32 s32, s32, 37888
    s_cmp_eq_u32 s32, 151552
    s_cselect_b32 s32, 0, s32

    s_add_u32 s34, s34, 1
    s_cmp_lt_u32 s34, 9
    s_cbranch_scc1 QK_LOOP

    s_waitcnt vmcnt(0) lgkmcnt(0)
    s_barrier

    v_cvt_pk_bf16_f32 v12, v100, v101
    v_cvt_pk_bf16_f32 v13, v102, v103
    ds_write_b32 v84, v12 offset:0
    ds_write_b32 v85, v13 offset:0
    v_cvt_pk_bf16_f32 v12, v120, v121
    v_cvt_pk_bf16_f32 v13, v122, v123
    ds_write_b32 v86, v12 offset:0
    ds_write_b32 v87, v13 offset:0
    v_cvt_pk_bf16_f32 v12, v140, v141
    v_cvt_pk_bf16_f32 v13, v142, v143
    ds_write_b32 v88, v12 offset:0
    ds_write_b32 v89, v13 offset:0
    v_cvt_pk_bf16_f32 v12, v160, v161
    v_cvt_pk_bf16_f32 v13, v162, v163
    ds_write_b32 v90, v12 offset:0
    ds_write_b32 v91, v13 offset:0
    v_cvt_pk_bf16_f32 v12, v180, v181
    v_cvt_pk_bf16_f32 v13, v182, v183
    ds_write_b32 v92, v12 offset:0
    ds_write_b32 v93, v13 offset:0
    v_cvt_pk_bf16_f32 v12, v200, v201
    v_cvt_pk_bf16_f32 v13, v202, v203
    ds_write_b32 v94, v12 offset:0
    ds_write_b32 v95, v13 offset:0
    v_cvt_pk_bf16_f32 v12, v220, v221
    v_cvt_pk_bf16_f32 v13, v222, v223
    ds_write_b32 v96, v12 offset:0
    ds_write_b32 v97, v13 offset:0
    v_cvt_pk_bf16_f32 v12, v104, v105
    v_cvt_pk_bf16_f32 v13, v106, v107
    ds_write_b32 v84, v12 offset:16000
    ds_write_b32 v85, v13 offset:16000
    v_cvt_pk_bf16_f32 v12, v124, v125
    v_cvt_pk_bf16_f32 v13, v126, v127
    ds_write_b32 v86, v12 offset:16000
    ds_write_b32 v87, v13 offset:16000
    v_cvt_pk_bf16_f32 v12, v144, v145
    v_cvt_pk_bf16_f32 v13, v146, v147
    ds_write_b32 v88, v12 offset:16000
    ds_write_b32 v89, v13 offset:16000
    v_cvt_pk_bf16_f32 v12, v164, v165
    v_cvt_pk_bf16_f32 v13, v166, v167
    ds_write_b32 v90, v12 offset:16000
    ds_write_b32 v91, v13 offset:16000
    v_cvt_pk_bf16_f32 v12, v184, v185
    v_cvt_pk_bf16_f32 v13, v186, v187
    ds_write_b32 v92, v12 offset:16000
    ds_write_b32 v93, v13 offset:16000
    v_cvt_pk_bf16_f32 v12, v204, v205
    v_cvt_pk_bf16_f32 v13, v206, v207
    ds_write_b32 v94, v12 offset:16000
    ds_write_b32 v95, v13 offset:16000
    v_cvt_pk_bf16_f32 v12, v224, v225
    v_cvt_pk_bf16_f32 v13, v226, v227
    ds_write_b32 v96, v12 offset:16000
    ds_write_b32 v97, v13 offset:16000
    v_cvt_pk_bf16_f32 v12, v108, v109
    v_cvt_pk_bf16_f32 v13, v110, v111
    ds_write_b32 v84, v12 offset:32000
    ds_write_b32 v85, v13 offset:32000
    v_cvt_pk_bf16_f32 v12, v128, v129
    v_cvt_pk_bf16_f32 v13, v130, v131
    ds_write_b32 v86, v12 offset:32000
    ds_write_b32 v87, v13 offset:32000
    v_cvt_pk_bf16_f32 v12, v148, v149
    v_cvt_pk_bf16_f32 v13, v150, v151
    ds_write_b32 v88, v12 offset:32000
    ds_write_b32 v89, v13 offset:32000
    v_cvt_pk_bf16_f32 v12, v168, v169
    v_cvt_pk_bf16_f32 v13, v170, v171
    ds_write_b32 v90, v12 offset:32000
    ds_write_b32 v91, v13 offset:32000
    v_cvt_pk_bf16_f32 v12, v188, v189
    v_cvt_pk_bf16_f32 v13, v190, v191
    ds_write_b32 v92, v12 offset:32000
    ds_write_b32 v93, v13 offset:32000
    v_cvt_pk_bf16_f32 v12, v208, v209
    v_cvt_pk_bf16_f32 v13, v210, v211
    ds_write_b32 v94, v12 offset:32000
    ds_write_b32 v95, v13 offset:32000
    v_cvt_pk_bf16_f32 v12, v228, v229
    v_cvt_pk_bf16_f32 v13, v230, v231
    ds_write_b32 v96, v12 offset:32000
    ds_write_b32 v97, v13 offset:32000
    v_cvt_pk_bf16_f32 v12, v112, v113
    v_cvt_pk_bf16_f32 v13, v114, v115
    ds_write_b32 v84, v12 offset:48000
    ds_write_b32 v85, v13 offset:48000
    v_cvt_pk_bf16_f32 v12, v132, v133
    v_cvt_pk_bf16_f32 v13, v134, v135
    ds_write_b32 v86, v12 offset:48000
    ds_write_b32 v87, v13 offset:48000
    v_cvt_pk_bf16_f32 v12, v152, v153
    v_cvt_pk_bf16_f32 v13, v154, v155
    ds_write_b32 v88, v12 offset:48000
    ds_write_b32 v89, v13 offset:48000
    v_cvt_pk_bf16_f32 v12, v172, v173
    v_cvt_pk_bf16_f32 v13, v174, v175
    ds_write_b32 v90, v12 offset:48000
    ds_write_b32 v91, v13 offset:48000
    v_cvt_pk_bf16_f32 v12, v192, v193
    v_cvt_pk_bf16_f32 v13, v194, v195
    ds_write_b32 v92, v12 offset:48000
    ds_write_b32 v93, v13 offset:48000
    v_cvt_pk_bf16_f32 v12, v212, v213
    v_cvt_pk_bf16_f32 v13, v214, v215
    ds_write_b32 v94, v12 offset:48000
    ds_write_b32 v95, v13 offset:48000
    v_cvt_pk_bf16_f32 v12, v232, v233
    v_cvt_pk_bf16_f32 v13, v234, v235
    ds_write_b32 v96, v12 offset:48000
    ds_write_b32 v97, v13 offset:48000
    v_cvt_pk_bf16_f32 v12, v116, v117
    v_cvt_pk_bf16_f32 v13, v118, v119
    ds_write_b32 v84, v12 offset:64000
    ds_write_b32 v85, v13 offset:64000
    v_cvt_pk_bf16_f32 v12, v136, v137
    v_cvt_pk_bf16_f32 v13, v138, v139
    ds_write_b32 v86, v12 offset:64000
    ds_write_b32 v87, v13 offset:64000
    v_cvt_pk_bf16_f32 v12, v156, v157
    v_cvt_pk_bf16_f32 v13, v158, v159
    ds_write_b32 v88, v12 offset:64000
    ds_write_b32 v89, v13 offset:64000
    v_cvt_pk_bf16_f32 v12, v176, v177
    v_cvt_pk_bf16_f32 v13, v178, v179
    ds_write_b32 v90, v12 offset:64000
    ds_write_b32 v91, v13 offset:64000
    v_cvt_pk_bf16_f32 v12, v196, v197
    v_cvt_pk_bf16_f32 v13, v198, v199
    ds_write_b32 v92, v12 offset:64000
    ds_write_b32 v93, v13 offset:64000
    v_cvt_pk_bf16_f32 v12, v216, v217
    v_cvt_pk_bf16_f32 v13, v218, v219
    ds_write_b32 v94, v12 offset:64000
    ds_write_b32 v95, v13 offset:64000
    v_cvt_pk_bf16_f32 v12, v236, v237
    v_cvt_pk_bf16_f32 v13, v238, v239
    ds_write_b32 v96, v12 offset:64000
    ds_write_b32 v97, v13 offset:64000
    s_waitcnt lgkmcnt(0)
    s_barrier

    s_mul_i32 s37, s3, 40
    s_mov_b32 s35, 0x3e715bef
    s_mov_b32 s43, 0x3fb8aa3b
    s_mov_b32 s61, 0x05040100
    s_mov_b32 s62, 0x07060302
    v_add_u32 v1, 0, v0
    v_add_u32 v2, 2, v1
    v_mul_u32_u24 v2, 1000, v2
    v_add_u32 v2, s37, v2
    s_lshl_b32 s38, s20, 7
    v_add_u32 v3, s38, v1

    ds_read_b64 v[16:17], v2 offset:14000
    ds_read_b64 v[18:19], v2 offset:14008
    ds_read_b64 v[20:21], v2 offset:14016
    ds_read_b64 v[22:23], v2 offset:14024
    ds_read_b32 v24, v2 offset:14032
    ds_read_b64 v[32:33], v2 offset:14320
    ds_read_b64 v[34:35], v2 offset:14328
    ds_read_b64 v[36:37], v2 offset:14336
    ds_read_b64 v[38:39], v2 offset:14344
    ds_read_b32 v40, v2 offset:14352
    ds_read_b64 v[42:43], v2 offset:12320
    ds_read_b64 v[44:45], v2 offset:12328
    ds_read_b64 v[46:47], v2 offset:12336
    ds_read_b64 v[48:49], v2 offset:12344
    ds_read_b32 v50, v2 offset:12352
    ds_read_b64 v[52:53], v2 offset:10320
    ds_read_b64 v[54:55], v2 offset:10328
    ds_read_b64 v[56:57], v2 offset:10336
    ds_read_b64 v[58:59], v2 offset:10344
    ds_read_b32 v60, v2 offset:10352
    ds_read_b64 v[62:63], v2 offset:8320
    ds_read_b64 v[64:65], v2 offset:8328
    ds_read_b64 v[66:67], v2 offset:8336
    ds_read_b64 v[68:69], v2 offset:8344
    ds_read_b32 v70, v2 offset:8352
    ds_read_b64 v[72:73], v2 offset:6320
    ds_read_b64 v[74:75], v2 offset:6328
    ds_read_b64 v[76:77], v2 offset:6336
    ds_read_b64 v[78:79], v2 offset:6344
    ds_read_b32 v80, v2 offset:6352
    ds_read_b64 v[82:83], v2 offset:4320
    ds_read_b64 v[84:85], v2 offset:4328
    ds_read_b64 v[86:87], v2 offset:4336
    ds_read_b64 v[88:89], v2 offset:4344
    ds_read_b32 v90, v2 offset:4352
    ds_read_b64 v[92:93], v2 offset:2320
    ds_read_b64 v[94:95], v2 offset:2328
    ds_read_b64 v[96:97], v2 offset:2336
    ds_read_b64 v[98:99], v2 offset:2344
    ds_read_b32 v100, v2 offset:2352
    ds_read_b64 v[102:103], v2 offset:320
    ds_read_b64 v[104:105], v2 offset:328
    ds_read_b64 v[106:107], v2 offset:336
    ds_read_b64 v[108:109], v2 offset:344
    ds_read_b32 v110, v2 offset:352
    ds_read_b64 v[152:153], v2 offset:14640
    ds_read_b64 v[154:155], v2 offset:14648
    ds_read_b64 v[156:157], v2 offset:14656
    ds_read_b64 v[158:159], v2 offset:14664
    ds_read_b32 v160, v2 offset:14672
    ds_read_b64 v[162:163], v2 offset:12640
    ds_read_b64 v[164:165], v2 offset:12648
    ds_read_b64 v[166:167], v2 offset:12656
    ds_read_b64 v[168:169], v2 offset:12664
    ds_read_b32 v170, v2 offset:12672
    ds_read_b64 v[172:173], v2 offset:10640
    ds_read_b64 v[174:175], v2 offset:10648
    ds_read_b64 v[176:177], v2 offset:10656
    ds_read_b64 v[178:179], v2 offset:10664
    ds_read_b32 v180, v2 offset:10672
    ds_read_b64 v[182:183], v2 offset:8640
    ds_read_b64 v[184:185], v2 offset:8648
    ds_read_b64 v[186:187], v2 offset:8656
    ds_read_b64 v[188:189], v2 offset:8664
    ds_read_b32 v190, v2 offset:8672
    ds_read_b64 v[192:193], v2 offset:6640
    ds_read_b64 v[194:195], v2 offset:6648
    ds_read_b64 v[196:197], v2 offset:6656
    ds_read_b64 v[198:199], v2 offset:6664
    ds_read_b32 v200, v2 offset:6672
    ds_read_b64 v[202:203], v2 offset:4640
    ds_read_b64 v[204:205], v2 offset:4648
    ds_read_b64 v[206:207], v2 offset:4656
    ds_read_b64 v[208:209], v2 offset:4664
    ds_read_b32 v210, v2 offset:4672
    ds_read_b64 v[212:213], v2 offset:2640
    ds_read_b64 v[214:215], v2 offset:2648
    ds_read_b64 v[216:217], v2 offset:2656
    ds_read_b64 v[218:219], v2 offset:2664
    ds_read_b32 v220, v2 offset:2672
    ds_read_b64 v[222:223], v2 offset:640
    ds_read_b64 v[224:225], v2 offset:648
    ds_read_b64 v[226:227], v2 offset:656
    ds_read_b64 v[228:229], v2 offset:664
    ds_read_b32 v230, v2 offset:672
    s_waitcnt lgkmcnt(15)
    v_mov_b32 v112, 0
    v_dot2_f32_bf16 v112, v16, v32, v112
    v_dot2_f32_bf16 v112, v17, v33, v112
    v_dot2_f32_bf16 v112, v18, v34, v112
    v_dot2_f32_bf16 v112, v19, v35, v112
    v_dot2_f32_bf16 v112, v20, v36, v112
    v_dot2_f32_bf16 v112, v21, v37, v112
    v_dot2_f32_bf16 v112, v22, v38, v112
    v_dot2_f32_bf16 v112, v23, v39, v112
    v_dot2_f32_bf16 v112, v24, v40, v112
    s_waitcnt lgkmcnt(15)
    v_mov_b32 v113, 0
    v_dot2_f32_bf16 v113, v16, v42, v113
    v_dot2_f32_bf16 v113, v17, v43, v113
    v_dot2_f32_bf16 v113, v18, v44, v113
    v_dot2_f32_bf16 v113, v19, v45, v113
    v_dot2_f32_bf16 v113, v20, v46, v113
    v_dot2_f32_bf16 v113, v21, v47, v113
    v_dot2_f32_bf16 v113, v22, v48, v113
    v_dot2_f32_bf16 v113, v23, v49, v113
    v_dot2_f32_bf16 v113, v24, v50, v113
    s_waitcnt lgkmcnt(15)
    v_mov_b32 v114, 0
    v_dot2_f32_bf16 v114, v16, v52, v114
    v_dot2_f32_bf16 v114, v17, v53, v114
    v_dot2_f32_bf16 v114, v18, v54, v114
    v_dot2_f32_bf16 v114, v19, v55, v114
    v_dot2_f32_bf16 v114, v20, v56, v114
    v_dot2_f32_bf16 v114, v21, v57, v114
    v_dot2_f32_bf16 v114, v22, v58, v114
    v_dot2_f32_bf16 v114, v23, v59, v114
    v_dot2_f32_bf16 v114, v24, v60, v114
    s_waitcnt lgkmcnt(15)
    v_mov_b32 v115, 0
    v_dot2_f32_bf16 v115, v16, v62, v115
    v_dot2_f32_bf16 v115, v17, v63, v115
    v_dot2_f32_bf16 v115, v18, v64, v115
    v_dot2_f32_bf16 v115, v19, v65, v115
    v_dot2_f32_bf16 v115, v20, v66, v115
    v_dot2_f32_bf16 v115, v21, v67, v115
    v_dot2_f32_bf16 v115, v22, v68, v115
    v_dot2_f32_bf16 v115, v23, v69, v115
    v_dot2_f32_bf16 v115, v24, v70, v115
    s_waitcnt lgkmcnt(15)
    v_mov_b32 v116, 0
    v_dot2_f32_bf16 v116, v16, v72, v116
    v_dot2_f32_bf16 v116, v17, v73, v116
    v_dot2_f32_bf16 v116, v18, v74, v116
    v_dot2_f32_bf16 v116, v19, v75, v116
    v_dot2_f32_bf16 v116, v20, v76, v116
    v_dot2_f32_bf16 v116, v21, v77, v116
    v_dot2_f32_bf16 v116, v22, v78, v116
    v_dot2_f32_bf16 v116, v23, v79, v116
    v_dot2_f32_bf16 v116, v24, v80, v116
    s_waitcnt lgkmcnt(15)
    v_mov_b32 v117, 0
    v_dot2_f32_bf16 v117, v16, v82, v117
    v_dot2_f32_bf16 v117, v17, v83, v117
    v_dot2_f32_bf16 v117, v18, v84, v117
    v_dot2_f32_bf16 v117, v19, v85, v117
    v_dot2_f32_bf16 v117, v20, v86, v117
    v_dot2_f32_bf16 v117, v21, v87, v117
    v_dot2_f32_bf16 v117, v22, v88, v117
    v_dot2_f32_bf16 v117, v23, v89, v117
    v_dot2_f32_bf16 v117, v24, v90, v117
    s_waitcnt lgkmcnt(15)
    v_mov_b32 v118, 0
    v_dot2_f32_bf16 v118, v16, v92, v118
    v_dot2_f32_bf16 v118, v17, v93, v118
    v_dot2_f32_bf16 v118, v18, v94, v118
    v_dot2_f32_bf16 v118, v19, v95, v118
    v_dot2_f32_bf16 v118, v20, v96, v118
    v_dot2_f32_bf16 v118, v21, v97, v118
    v_dot2_f32_bf16 v118, v22, v98, v118
    v_dot2_f32_bf16 v118, v23, v99, v118
    v_dot2_f32_bf16 v118, v24, v100, v118
    s_waitcnt lgkmcnt(15)
    v_mov_b32 v119, 0
    v_dot2_f32_bf16 v119, v16, v102, v119
    v_dot2_f32_bf16 v119, v17, v103, v119
    v_dot2_f32_bf16 v119, v18, v104, v119
    v_dot2_f32_bf16 v119, v19, v105, v119
    v_dot2_f32_bf16 v119, v20, v106, v119
    v_dot2_f32_bf16 v119, v21, v107, v119
    v_dot2_f32_bf16 v119, v22, v108, v119
    v_dot2_f32_bf16 v119, v23, v109, v119
    v_dot2_f32_bf16 v119, v24, v110, v119
    v_mov_b32 v5, 0xce6e0000
    v_cvt_pk_bf16_f32 v6, v112, v113
    v_lshlrev_b32 v112, 16, v6
    v_and_b32 v113, 0xffff0000, v6
    v_mul_f32 v112, s35, v112
    v_mul_f32 v113, s35, v113
    v_cvt_pk_bf16_f32 v6, v112, v113
    v_lshlrev_b32 v112, 16, v6
    v_and_b32 v113, 0xffff0000, v6

    v_cvt_pk_bf16_f32 v6, v114, v115
    v_lshlrev_b32 v114, 16, v6
    v_and_b32 v115, 0xffff0000, v6
    v_mul_f32 v114, s35, v114
    v_mul_f32 v115, s35, v115
    v_cvt_pk_bf16_f32 v6, v114, v115
    v_lshlrev_b32 v114, 16, v6
    v_and_b32 v115, 0xffff0000, v6

    v_cvt_pk_bf16_f32 v6, v116, v117
    v_lshlrev_b32 v116, 16, v6
    v_and_b32 v117, 0xffff0000, v6
    v_mul_f32 v116, s35, v116
    v_mul_f32 v117, s35, v117
    v_cvt_pk_bf16_f32 v6, v116, v117
    v_lshlrev_b32 v116, 16, v6
    v_and_b32 v117, 0xffff0000, v6

    v_cvt_pk_bf16_f32 v6, v118, v119
    v_lshlrev_b32 v118, 16, v6
    v_and_b32 v119, 0xffff0000, v6
    v_mul_f32 v118, s35, v118
    v_mul_f32 v119, s35, v119
    v_cvt_pk_bf16_f32 v6, v118, v119
    v_lshlrev_b32 v118, 16, v6
    v_and_b32 v119, 0xffff0000, v6

    v_cmp_gt_u32 vcc, 2, v3
    s_nop 1
    v_cndmask_b32 v113, v113, v5, vcc

    v_cmp_gt_u32 vcc, 4, v3
    s_nop 1
    v_cndmask_b32 v114, v114, v5, vcc

    v_cmp_gt_u32 vcc, 6, v3
    s_nop 1
    v_cndmask_b32 v115, v115, v5, vcc

    v_cmp_gt_u32 vcc, 8, v3
    s_nop 1
    v_cndmask_b32 v116, v116, v5, vcc

    v_cmp_gt_u32 vcc, 10, v3
    s_nop 1
    v_cndmask_b32 v117, v117, v5, vcc

    v_cmp_gt_u32 vcc, 12, v3
    s_nop 1
    v_cndmask_b32 v118, v118, v5, vcc

    v_cmp_gt_u32 vcc, 14, v3
    s_nop 1
    v_cndmask_b32 v119, v119, v5, vcc

    v_max3_f32 v6, v112, v113, v114
    v_max3_f32 v6, v6, v115, v116
    v_max3_f32 v6, v6, v117, v118
    v_max_f32 v6, v6, v119

    v_sub_f32 v112, v112, v6
    v_mul_f32 v112, s43, v112
    v_exp_f32 v112, v112
    v_sub_f32 v113, v113, v6
    v_mul_f32 v113, s43, v113
    v_exp_f32 v113, v113
    v_sub_f32 v114, v114, v6
    v_mul_f32 v114, s43, v114
    v_exp_f32 v114, v114
    v_sub_f32 v115, v115, v6
    v_mul_f32 v115, s43, v115
    v_exp_f32 v115, v115
    v_sub_f32 v116, v116, v6
    v_mul_f32 v116, s43, v116
    v_exp_f32 v116, v116
    v_sub_f32 v117, v117, v6
    v_mul_f32 v117, s43, v117
    v_exp_f32 v117, v117
    v_sub_f32 v118, v118, v6
    v_mul_f32 v118, s43, v118
    v_exp_f32 v118, v118
    v_sub_f32 v119, v119, v6
    v_mul_f32 v119, s43, v119
    v_exp_f32 v119, v119
    s_nop 0
    v_add_f32 v6, v112, v113
    v_add_f32 v7, v114, v115
    v_add_f32 v8, v116, v117
    v_add_f32 v9, v118, v119
    v_add_f32 v6, v6, v7
    v_add_f32 v8, v8, v9
    v_add_f32 v6, v6, v8
    v_rcp_f32 v6, v6
    s_nop 0

    v_mul_f32 v112, v112, v6
    v_mul_f32 v113, v113, v6
    v_mul_f32 v114, v114, v6
    v_mul_f32 v115, v115, v6
    v_mul_f32 v116, v116, v6
    v_mul_f32 v117, v117, v6
    v_mul_f32 v118, v118, v6
    v_mul_f32 v119, v119, v6
    v_cvt_pk_bf16_f32 v120, v112, v113
    v_cvt_pk_bf16_f32 v121, v114, v115
    v_cvt_pk_bf16_f32 v122, v116, v117
    v_cvt_pk_bf16_f32 v123, v118, v119
    v_mov_b32 v124, 0
    v_mov_b32 v125, 0
    v_mov_b32 v126, 0
    v_mov_b32 v127, 0
    v_mov_b32 v128, 0
    v_mov_b32 v129, 0
    v_mov_b32 v130, 0
    v_mov_b32 v131, 0
    v_mov_b32 v132, 0
    v_mov_b32 v133, 0
    v_mov_b32 v134, 0
    v_mov_b32 v135, 0
    v_mov_b32 v136, 0
    v_mov_b32 v137, 0
    v_mov_b32 v138, 0
    v_mov_b32 v139, 0
    v_mov_b32 v140, 0
    v_mov_b32 v141, 0
    s_waitcnt lgkmcnt(0)
    v_perm_b32 v6, v162, v152, s61
    v_perm_b32 v7, v162, v152, s62
    v_dot2_f32_bf16 v124, v6, v120, v124
    v_dot2_f32_bf16 v125, v7, v120, v125

    v_perm_b32 v6, v163, v153, s61
    v_perm_b32 v7, v163, v153, s62
    v_dot2_f32_bf16 v126, v6, v120, v126
    v_dot2_f32_bf16 v127, v7, v120, v127

    v_perm_b32 v6, v164, v154, s61
    v_perm_b32 v7, v164, v154, s62
    v_dot2_f32_bf16 v128, v6, v120, v128
    v_dot2_f32_bf16 v129, v7, v120, v129

    v_perm_b32 v6, v165, v155, s61
    v_perm_b32 v7, v165, v155, s62
    v_dot2_f32_bf16 v130, v6, v120, v130
    v_dot2_f32_bf16 v131, v7, v120, v131

    v_perm_b32 v6, v166, v156, s61
    v_perm_b32 v7, v166, v156, s62
    v_dot2_f32_bf16 v132, v6, v120, v132
    v_dot2_f32_bf16 v133, v7, v120, v133

    v_perm_b32 v6, v167, v157, s61
    v_perm_b32 v7, v167, v157, s62
    v_dot2_f32_bf16 v134, v6, v120, v134
    v_dot2_f32_bf16 v135, v7, v120, v135

    v_perm_b32 v6, v168, v158, s61
    v_perm_b32 v7, v168, v158, s62
    v_dot2_f32_bf16 v136, v6, v120, v136
    v_dot2_f32_bf16 v137, v7, v120, v137

    v_perm_b32 v6, v169, v159, s61
    v_perm_b32 v7, v169, v159, s62
    v_dot2_f32_bf16 v138, v6, v120, v138
    v_dot2_f32_bf16 v139, v7, v120, v139

    v_perm_b32 v6, v170, v160, s61
    v_perm_b32 v7, v170, v160, s62
    v_dot2_f32_bf16 v140, v6, v120, v140
    v_dot2_f32_bf16 v141, v7, v120, v141

    v_perm_b32 v6, v182, v172, s61
    v_perm_b32 v7, v182, v172, s62
    v_dot2_f32_bf16 v124, v6, v121, v124
    v_dot2_f32_bf16 v125, v7, v121, v125

    v_perm_b32 v6, v183, v173, s61
    v_perm_b32 v7, v183, v173, s62
    v_dot2_f32_bf16 v126, v6, v121, v126
    v_dot2_f32_bf16 v127, v7, v121, v127

    v_perm_b32 v6, v184, v174, s61
    v_perm_b32 v7, v184, v174, s62
    v_dot2_f32_bf16 v128, v6, v121, v128
    v_dot2_f32_bf16 v129, v7, v121, v129

    v_perm_b32 v6, v185, v175, s61
    v_perm_b32 v7, v185, v175, s62
    v_dot2_f32_bf16 v130, v6, v121, v130
    v_dot2_f32_bf16 v131, v7, v121, v131

    v_perm_b32 v6, v186, v176, s61
    v_perm_b32 v7, v186, v176, s62
    v_dot2_f32_bf16 v132, v6, v121, v132
    v_dot2_f32_bf16 v133, v7, v121, v133

    v_perm_b32 v6, v187, v177, s61
    v_perm_b32 v7, v187, v177, s62
    v_dot2_f32_bf16 v134, v6, v121, v134
    v_dot2_f32_bf16 v135, v7, v121, v135

    v_perm_b32 v6, v188, v178, s61
    v_perm_b32 v7, v188, v178, s62
    v_dot2_f32_bf16 v136, v6, v121, v136
    v_dot2_f32_bf16 v137, v7, v121, v137

    v_perm_b32 v6, v189, v179, s61
    v_perm_b32 v7, v189, v179, s62
    v_dot2_f32_bf16 v138, v6, v121, v138
    v_dot2_f32_bf16 v139, v7, v121, v139

    v_perm_b32 v6, v190, v180, s61
    v_perm_b32 v7, v190, v180, s62
    v_dot2_f32_bf16 v140, v6, v121, v140
    v_dot2_f32_bf16 v141, v7, v121, v141

    v_perm_b32 v6, v202, v192, s61
    v_perm_b32 v7, v202, v192, s62
    v_dot2_f32_bf16 v124, v6, v122, v124
    v_dot2_f32_bf16 v125, v7, v122, v125

    v_perm_b32 v6, v203, v193, s61
    v_perm_b32 v7, v203, v193, s62
    v_dot2_f32_bf16 v126, v6, v122, v126
    v_dot2_f32_bf16 v127, v7, v122, v127

    v_perm_b32 v6, v204, v194, s61
    v_perm_b32 v7, v204, v194, s62
    v_dot2_f32_bf16 v128, v6, v122, v128
    v_dot2_f32_bf16 v129, v7, v122, v129

    v_perm_b32 v6, v205, v195, s61
    v_perm_b32 v7, v205, v195, s62
    v_dot2_f32_bf16 v130, v6, v122, v130
    v_dot2_f32_bf16 v131, v7, v122, v131

    v_perm_b32 v6, v206, v196, s61
    v_perm_b32 v7, v206, v196, s62
    v_dot2_f32_bf16 v132, v6, v122, v132
    v_dot2_f32_bf16 v133, v7, v122, v133

    v_perm_b32 v6, v207, v197, s61
    v_perm_b32 v7, v207, v197, s62
    v_dot2_f32_bf16 v134, v6, v122, v134
    v_dot2_f32_bf16 v135, v7, v122, v135

    v_perm_b32 v6, v208, v198, s61
    v_perm_b32 v7, v208, v198, s62
    v_dot2_f32_bf16 v136, v6, v122, v136
    v_dot2_f32_bf16 v137, v7, v122, v137

    v_perm_b32 v6, v209, v199, s61
    v_perm_b32 v7, v209, v199, s62
    v_dot2_f32_bf16 v138, v6, v122, v138
    v_dot2_f32_bf16 v139, v7, v122, v139

    v_perm_b32 v6, v210, v200, s61
    v_perm_b32 v7, v210, v200, s62
    v_dot2_f32_bf16 v140, v6, v122, v140
    v_dot2_f32_bf16 v141, v7, v122, v141

    v_perm_b32 v6, v222, v212, s61
    v_perm_b32 v7, v222, v212, s62
    v_dot2_f32_bf16 v124, v6, v123, v124
    v_dot2_f32_bf16 v125, v7, v123, v125

    v_perm_b32 v6, v223, v213, s61
    v_perm_b32 v7, v223, v213, s62
    v_dot2_f32_bf16 v126, v6, v123, v126
    v_dot2_f32_bf16 v127, v7, v123, v127

    v_perm_b32 v6, v224, v214, s61
    v_perm_b32 v7, v224, v214, s62
    v_dot2_f32_bf16 v128, v6, v123, v128
    v_dot2_f32_bf16 v129, v7, v123, v129

    v_perm_b32 v6, v225, v215, s61
    v_perm_b32 v7, v225, v215, s62
    v_dot2_f32_bf16 v130, v6, v123, v130
    v_dot2_f32_bf16 v131, v7, v123, v131

    v_perm_b32 v6, v226, v216, s61
    v_perm_b32 v7, v226, v216, s62
    v_dot2_f32_bf16 v132, v6, v123, v132
    v_dot2_f32_bf16 v133, v7, v123, v133

    v_perm_b32 v6, v227, v217, s61
    v_perm_b32 v7, v227, v217, s62
    v_dot2_f32_bf16 v134, v6, v123, v134
    v_dot2_f32_bf16 v135, v7, v123, v135

    v_perm_b32 v6, v228, v218, s61
    v_perm_b32 v7, v228, v218, s62
    v_dot2_f32_bf16 v136, v6, v123, v136
    v_dot2_f32_bf16 v137, v7, v123, v137

    v_perm_b32 v6, v229, v219, s61
    v_perm_b32 v7, v229, v219, s62
    v_dot2_f32_bf16 v138, v6, v123, v138
    v_dot2_f32_bf16 v139, v7, v123, v139

    v_perm_b32 v6, v230, v220, s61
    v_perm_b32 v7, v230, v220, s62
    v_dot2_f32_bf16 v140, v6, v123, v140
    v_dot2_f32_bf16 v141, v7, v123, v141

    v_cvt_pk_bf16_f32 v232, v124, v125
    v_cvt_pk_bf16_f32 v233, v126, v127
    v_cvt_pk_bf16_f32 v234, v128, v129
    v_cvt_pk_bf16_f32 v235, v130, v131
    v_cvt_pk_bf16_f32 v236, v132, v133
    v_cvt_pk_bf16_f32 v237, v134, v135
    v_cvt_pk_bf16_f32 v238, v136, v137
    v_cvt_pk_bf16_f32 v239, v138, v139
    v_cvt_pk_bf16_f32 v240, v140, v141
    v_add_u32 v1, 64, v0
    v_add_u32 v2, 2, v1
    v_mul_u32_u24 v2, 1000, v2
    v_add_u32 v2, s37, v2
    s_lshl_b32 s38, s20, 7
    v_add_u32 v3, s38, v1

    ds_read_b64 v[16:17], v2 offset:14000
    ds_read_b64 v[18:19], v2 offset:14008
    ds_read_b64 v[20:21], v2 offset:14016
    ds_read_b64 v[22:23], v2 offset:14024
    ds_read_b32 v24, v2 offset:14032
    ds_read_b64 v[32:33], v2 offset:14320
    ds_read_b64 v[34:35], v2 offset:14328
    ds_read_b64 v[36:37], v2 offset:14336
    ds_read_b64 v[38:39], v2 offset:14344
    ds_read_b32 v40, v2 offset:14352
    ds_read_b64 v[42:43], v2 offset:12320
    ds_read_b64 v[44:45], v2 offset:12328
    ds_read_b64 v[46:47], v2 offset:12336
    ds_read_b64 v[48:49], v2 offset:12344
    ds_read_b32 v50, v2 offset:12352
    ds_read_b64 v[52:53], v2 offset:10320
    ds_read_b64 v[54:55], v2 offset:10328
    ds_read_b64 v[56:57], v2 offset:10336
    ds_read_b64 v[58:59], v2 offset:10344
    ds_read_b32 v60, v2 offset:10352
    ds_read_b64 v[62:63], v2 offset:8320
    ds_read_b64 v[64:65], v2 offset:8328
    ds_read_b64 v[66:67], v2 offset:8336
    ds_read_b64 v[68:69], v2 offset:8344
    ds_read_b32 v70, v2 offset:8352
    ds_read_b64 v[72:73], v2 offset:6320
    ds_read_b64 v[74:75], v2 offset:6328
    ds_read_b64 v[76:77], v2 offset:6336
    ds_read_b64 v[78:79], v2 offset:6344
    ds_read_b32 v80, v2 offset:6352
    ds_read_b64 v[82:83], v2 offset:4320
    ds_read_b64 v[84:85], v2 offset:4328
    ds_read_b64 v[86:87], v2 offset:4336
    ds_read_b64 v[88:89], v2 offset:4344
    ds_read_b32 v90, v2 offset:4352
    ds_read_b64 v[92:93], v2 offset:2320
    ds_read_b64 v[94:95], v2 offset:2328
    ds_read_b64 v[96:97], v2 offset:2336
    ds_read_b64 v[98:99], v2 offset:2344
    ds_read_b32 v100, v2 offset:2352
    ds_read_b64 v[102:103], v2 offset:320
    ds_read_b64 v[104:105], v2 offset:328
    ds_read_b64 v[106:107], v2 offset:336
    ds_read_b64 v[108:109], v2 offset:344
    ds_read_b32 v110, v2 offset:352
    ds_read_b64 v[152:153], v2 offset:14640
    ds_read_b64 v[154:155], v2 offset:14648
    ds_read_b64 v[156:157], v2 offset:14656
    ds_read_b64 v[158:159], v2 offset:14664
    ds_read_b32 v160, v2 offset:14672
    ds_read_b64 v[162:163], v2 offset:12640
    ds_read_b64 v[164:165], v2 offset:12648
    ds_read_b64 v[166:167], v2 offset:12656
    ds_read_b64 v[168:169], v2 offset:12664
    ds_read_b32 v170, v2 offset:12672
    ds_read_b64 v[172:173], v2 offset:10640
    ds_read_b64 v[174:175], v2 offset:10648
    ds_read_b64 v[176:177], v2 offset:10656
    ds_read_b64 v[178:179], v2 offset:10664
    ds_read_b32 v180, v2 offset:10672
    ds_read_b64 v[182:183], v2 offset:8640
    ds_read_b64 v[184:185], v2 offset:8648
    ds_read_b64 v[186:187], v2 offset:8656
    ds_read_b64 v[188:189], v2 offset:8664
    ds_read_b32 v190, v2 offset:8672
    ds_read_b64 v[192:193], v2 offset:6640
    ds_read_b64 v[194:195], v2 offset:6648
    ds_read_b64 v[196:197], v2 offset:6656
    ds_read_b64 v[198:199], v2 offset:6664
    ds_read_b32 v200, v2 offset:6672
    ds_read_b64 v[202:203], v2 offset:4640
    ds_read_b64 v[204:205], v2 offset:4648
    ds_read_b64 v[206:207], v2 offset:4656
    ds_read_b64 v[208:209], v2 offset:4664
    ds_read_b32 v210, v2 offset:4672
    ds_read_b64 v[212:213], v2 offset:2640
    ds_read_b64 v[214:215], v2 offset:2648
    ds_read_b64 v[216:217], v2 offset:2656
    ds_read_b64 v[218:219], v2 offset:2664
    ds_read_b32 v220, v2 offset:2672
    ds_read_b64 v[222:223], v2 offset:640
    ds_read_b64 v[224:225], v2 offset:648
    ds_read_b64 v[226:227], v2 offset:656
    ds_read_b64 v[228:229], v2 offset:664
    ds_read_b32 v230, v2 offset:672
    s_waitcnt lgkmcnt(15)
    v_mov_b32 v112, 0
    v_dot2_f32_bf16 v112, v16, v32, v112
    v_dot2_f32_bf16 v112, v17, v33, v112
    v_dot2_f32_bf16 v112, v18, v34, v112
    v_dot2_f32_bf16 v112, v19, v35, v112
    v_dot2_f32_bf16 v112, v20, v36, v112
    v_dot2_f32_bf16 v112, v21, v37, v112
    v_dot2_f32_bf16 v112, v22, v38, v112
    v_dot2_f32_bf16 v112, v23, v39, v112
    v_dot2_f32_bf16 v112, v24, v40, v112
    s_waitcnt lgkmcnt(15)
    v_mov_b32 v113, 0
    v_dot2_f32_bf16 v113, v16, v42, v113
    v_dot2_f32_bf16 v113, v17, v43, v113
    v_dot2_f32_bf16 v113, v18, v44, v113
    v_dot2_f32_bf16 v113, v19, v45, v113
    v_dot2_f32_bf16 v113, v20, v46, v113
    v_dot2_f32_bf16 v113, v21, v47, v113
    v_dot2_f32_bf16 v113, v22, v48, v113
    v_dot2_f32_bf16 v113, v23, v49, v113
    v_dot2_f32_bf16 v113, v24, v50, v113
    s_waitcnt lgkmcnt(15)
    v_mov_b32 v114, 0
    v_dot2_f32_bf16 v114, v16, v52, v114
    v_dot2_f32_bf16 v114, v17, v53, v114
    v_dot2_f32_bf16 v114, v18, v54, v114
    v_dot2_f32_bf16 v114, v19, v55, v114
    v_dot2_f32_bf16 v114, v20, v56, v114
    v_dot2_f32_bf16 v114, v21, v57, v114
    v_dot2_f32_bf16 v114, v22, v58, v114
    v_dot2_f32_bf16 v114, v23, v59, v114
    v_dot2_f32_bf16 v114, v24, v60, v114
    s_waitcnt lgkmcnt(15)
    v_mov_b32 v115, 0
    v_dot2_f32_bf16 v115, v16, v62, v115
    v_dot2_f32_bf16 v115, v17, v63, v115
    v_dot2_f32_bf16 v115, v18, v64, v115
    v_dot2_f32_bf16 v115, v19, v65, v115
    v_dot2_f32_bf16 v115, v20, v66, v115
    v_dot2_f32_bf16 v115, v21, v67, v115
    v_dot2_f32_bf16 v115, v22, v68, v115
    v_dot2_f32_bf16 v115, v23, v69, v115
    v_dot2_f32_bf16 v115, v24, v70, v115
    s_waitcnt lgkmcnt(15)
    v_mov_b32 v116, 0
    v_dot2_f32_bf16 v116, v16, v72, v116
    v_dot2_f32_bf16 v116, v17, v73, v116
    v_dot2_f32_bf16 v116, v18, v74, v116
    v_dot2_f32_bf16 v116, v19, v75, v116
    v_dot2_f32_bf16 v116, v20, v76, v116
    v_dot2_f32_bf16 v116, v21, v77, v116
    v_dot2_f32_bf16 v116, v22, v78, v116
    v_dot2_f32_bf16 v116, v23, v79, v116
    v_dot2_f32_bf16 v116, v24, v80, v116
    s_waitcnt lgkmcnt(15)
    v_mov_b32 v117, 0
    v_dot2_f32_bf16 v117, v16, v82, v117
    v_dot2_f32_bf16 v117, v17, v83, v117
    v_dot2_f32_bf16 v117, v18, v84, v117
    v_dot2_f32_bf16 v117, v19, v85, v117
    v_dot2_f32_bf16 v117, v20, v86, v117
    v_dot2_f32_bf16 v117, v21, v87, v117
    v_dot2_f32_bf16 v117, v22, v88, v117
    v_dot2_f32_bf16 v117, v23, v89, v117
    v_dot2_f32_bf16 v117, v24, v90, v117
    s_waitcnt lgkmcnt(15)
    v_mov_b32 v118, 0
    v_dot2_f32_bf16 v118, v16, v92, v118
    v_dot2_f32_bf16 v118, v17, v93, v118
    v_dot2_f32_bf16 v118, v18, v94, v118
    v_dot2_f32_bf16 v118, v19, v95, v118
    v_dot2_f32_bf16 v118, v20, v96, v118
    v_dot2_f32_bf16 v118, v21, v97, v118
    v_dot2_f32_bf16 v118, v22, v98, v118
    v_dot2_f32_bf16 v118, v23, v99, v118
    v_dot2_f32_bf16 v118, v24, v100, v118
    s_waitcnt lgkmcnt(15)
    v_mov_b32 v119, 0
    v_dot2_f32_bf16 v119, v16, v102, v119
    v_dot2_f32_bf16 v119, v17, v103, v119
    v_dot2_f32_bf16 v119, v18, v104, v119
    v_dot2_f32_bf16 v119, v19, v105, v119
    v_dot2_f32_bf16 v119, v20, v106, v119
    v_dot2_f32_bf16 v119, v21, v107, v119
    v_dot2_f32_bf16 v119, v22, v108, v119
    v_dot2_f32_bf16 v119, v23, v109, v119
    v_dot2_f32_bf16 v119, v24, v110, v119
    v_mov_b32 v5, 0xce6e0000
    v_cvt_pk_bf16_f32 v6, v112, v113
    v_lshlrev_b32 v112, 16, v6
    v_and_b32 v113, 0xffff0000, v6
    v_mul_f32 v112, s35, v112
    v_mul_f32 v113, s35, v113
    v_cvt_pk_bf16_f32 v6, v112, v113
    v_lshlrev_b32 v112, 16, v6
    v_and_b32 v113, 0xffff0000, v6

    v_cvt_pk_bf16_f32 v6, v114, v115
    v_lshlrev_b32 v114, 16, v6
    v_and_b32 v115, 0xffff0000, v6
    v_mul_f32 v114, s35, v114
    v_mul_f32 v115, s35, v115
    v_cvt_pk_bf16_f32 v6, v114, v115
    v_lshlrev_b32 v114, 16, v6
    v_and_b32 v115, 0xffff0000, v6

    v_cvt_pk_bf16_f32 v6, v116, v117
    v_lshlrev_b32 v116, 16, v6
    v_and_b32 v117, 0xffff0000, v6
    v_mul_f32 v116, s35, v116
    v_mul_f32 v117, s35, v117
    v_cvt_pk_bf16_f32 v6, v116, v117
    v_lshlrev_b32 v116, 16, v6
    v_and_b32 v117, 0xffff0000, v6

    v_cvt_pk_bf16_f32 v6, v118, v119
    v_lshlrev_b32 v118, 16, v6
    v_and_b32 v119, 0xffff0000, v6
    v_mul_f32 v118, s35, v118
    v_mul_f32 v119, s35, v119
    v_cvt_pk_bf16_f32 v6, v118, v119
    v_lshlrev_b32 v118, 16, v6
    v_and_b32 v119, 0xffff0000, v6

    v_cmp_gt_u32 vcc, 2, v3
    s_nop 1
    v_cndmask_b32 v113, v113, v5, vcc

    v_cmp_gt_u32 vcc, 4, v3
    s_nop 1
    v_cndmask_b32 v114, v114, v5, vcc

    v_cmp_gt_u32 vcc, 6, v3
    s_nop 1
    v_cndmask_b32 v115, v115, v5, vcc

    v_cmp_gt_u32 vcc, 8, v3
    s_nop 1
    v_cndmask_b32 v116, v116, v5, vcc

    v_cmp_gt_u32 vcc, 10, v3
    s_nop 1
    v_cndmask_b32 v117, v117, v5, vcc

    v_cmp_gt_u32 vcc, 12, v3
    s_nop 1
    v_cndmask_b32 v118, v118, v5, vcc

    v_cmp_gt_u32 vcc, 14, v3
    s_nop 1
    v_cndmask_b32 v119, v119, v5, vcc

    v_max3_f32 v6, v112, v113, v114
    v_max3_f32 v6, v6, v115, v116
    v_max3_f32 v6, v6, v117, v118
    v_max_f32 v6, v6, v119

    v_sub_f32 v112, v112, v6
    v_mul_f32 v112, s43, v112
    v_exp_f32 v112, v112
    v_sub_f32 v113, v113, v6
    v_mul_f32 v113, s43, v113
    v_exp_f32 v113, v113
    v_sub_f32 v114, v114, v6
    v_mul_f32 v114, s43, v114
    v_exp_f32 v114, v114
    v_sub_f32 v115, v115, v6
    v_mul_f32 v115, s43, v115
    v_exp_f32 v115, v115
    v_sub_f32 v116, v116, v6
    v_mul_f32 v116, s43, v116
    v_exp_f32 v116, v116
    v_sub_f32 v117, v117, v6
    v_mul_f32 v117, s43, v117
    v_exp_f32 v117, v117
    v_sub_f32 v118, v118, v6
    v_mul_f32 v118, s43, v118
    v_exp_f32 v118, v118
    v_sub_f32 v119, v119, v6
    v_mul_f32 v119, s43, v119
    v_exp_f32 v119, v119
    s_nop 0
    v_add_f32 v6, v112, v113
    v_add_f32 v7, v114, v115
    v_add_f32 v8, v116, v117
    v_add_f32 v9, v118, v119
    v_add_f32 v6, v6, v7
    v_add_f32 v8, v8, v9
    v_add_f32 v6, v6, v8
    v_rcp_f32 v6, v6
    s_nop 0

    v_mul_f32 v112, v112, v6
    v_mul_f32 v113, v113, v6
    v_mul_f32 v114, v114, v6
    v_mul_f32 v115, v115, v6
    v_mul_f32 v116, v116, v6
    v_mul_f32 v117, v117, v6
    v_mul_f32 v118, v118, v6
    v_mul_f32 v119, v119, v6
    v_cvt_pk_bf16_f32 v120, v112, v113
    v_cvt_pk_bf16_f32 v121, v114, v115
    v_cvt_pk_bf16_f32 v122, v116, v117
    v_cvt_pk_bf16_f32 v123, v118, v119
    v_mov_b32 v124, 0
    v_mov_b32 v125, 0
    v_mov_b32 v126, 0
    v_mov_b32 v127, 0
    v_mov_b32 v128, 0
    v_mov_b32 v129, 0
    v_mov_b32 v130, 0
    v_mov_b32 v131, 0
    v_mov_b32 v132, 0
    v_mov_b32 v133, 0
    v_mov_b32 v134, 0
    v_mov_b32 v135, 0
    v_mov_b32 v136, 0
    v_mov_b32 v137, 0
    v_mov_b32 v138, 0
    v_mov_b32 v139, 0
    v_mov_b32 v140, 0
    v_mov_b32 v141, 0
    s_waitcnt lgkmcnt(0)
    v_perm_b32 v6, v162, v152, s61
    v_perm_b32 v7, v162, v152, s62
    v_dot2_f32_bf16 v124, v6, v120, v124
    v_dot2_f32_bf16 v125, v7, v120, v125

    v_perm_b32 v6, v163, v153, s61
    v_perm_b32 v7, v163, v153, s62
    v_dot2_f32_bf16 v126, v6, v120, v126
    v_dot2_f32_bf16 v127, v7, v120, v127

    v_perm_b32 v6, v164, v154, s61
    v_perm_b32 v7, v164, v154, s62
    v_dot2_f32_bf16 v128, v6, v120, v128
    v_dot2_f32_bf16 v129, v7, v120, v129

    v_perm_b32 v6, v165, v155, s61
    v_perm_b32 v7, v165, v155, s62
    v_dot2_f32_bf16 v130, v6, v120, v130
    v_dot2_f32_bf16 v131, v7, v120, v131

    v_perm_b32 v6, v166, v156, s61
    v_perm_b32 v7, v166, v156, s62
    v_dot2_f32_bf16 v132, v6, v120, v132
    v_dot2_f32_bf16 v133, v7, v120, v133

    v_perm_b32 v6, v167, v157, s61
    v_perm_b32 v7, v167, v157, s62
    v_dot2_f32_bf16 v134, v6, v120, v134
    v_dot2_f32_bf16 v135, v7, v120, v135

    v_perm_b32 v6, v168, v158, s61
    v_perm_b32 v7, v168, v158, s62
    v_dot2_f32_bf16 v136, v6, v120, v136
    v_dot2_f32_bf16 v137, v7, v120, v137

    v_perm_b32 v6, v169, v159, s61
    v_perm_b32 v7, v169, v159, s62
    v_dot2_f32_bf16 v138, v6, v120, v138
    v_dot2_f32_bf16 v139, v7, v120, v139

    v_perm_b32 v6, v170, v160, s61
    v_perm_b32 v7, v170, v160, s62
    v_dot2_f32_bf16 v140, v6, v120, v140
    v_dot2_f32_bf16 v141, v7, v120, v141

    v_perm_b32 v6, v182, v172, s61
    v_perm_b32 v7, v182, v172, s62
    v_dot2_f32_bf16 v124, v6, v121, v124
    v_dot2_f32_bf16 v125, v7, v121, v125

    v_perm_b32 v6, v183, v173, s61
    v_perm_b32 v7, v183, v173, s62
    v_dot2_f32_bf16 v126, v6, v121, v126
    v_dot2_f32_bf16 v127, v7, v121, v127

    v_perm_b32 v6, v184, v174, s61
    v_perm_b32 v7, v184, v174, s62
    v_dot2_f32_bf16 v128, v6, v121, v128
    v_dot2_f32_bf16 v129, v7, v121, v129

    v_perm_b32 v6, v185, v175, s61
    v_perm_b32 v7, v185, v175, s62
    v_dot2_f32_bf16 v130, v6, v121, v130
    v_dot2_f32_bf16 v131, v7, v121, v131

    v_perm_b32 v6, v186, v176, s61
    v_perm_b32 v7, v186, v176, s62
    v_dot2_f32_bf16 v132, v6, v121, v132
    v_dot2_f32_bf16 v133, v7, v121, v133

    v_perm_b32 v6, v187, v177, s61
    v_perm_b32 v7, v187, v177, s62
    v_dot2_f32_bf16 v134, v6, v121, v134
    v_dot2_f32_bf16 v135, v7, v121, v135

    v_perm_b32 v6, v188, v178, s61
    v_perm_b32 v7, v188, v178, s62
    v_dot2_f32_bf16 v136, v6, v121, v136
    v_dot2_f32_bf16 v137, v7, v121, v137

    v_perm_b32 v6, v189, v179, s61
    v_perm_b32 v7, v189, v179, s62
    v_dot2_f32_bf16 v138, v6, v121, v138
    v_dot2_f32_bf16 v139, v7, v121, v139

    v_perm_b32 v6, v190, v180, s61
    v_perm_b32 v7, v190, v180, s62
    v_dot2_f32_bf16 v140, v6, v121, v140
    v_dot2_f32_bf16 v141, v7, v121, v141

    v_perm_b32 v6, v202, v192, s61
    v_perm_b32 v7, v202, v192, s62
    v_dot2_f32_bf16 v124, v6, v122, v124
    v_dot2_f32_bf16 v125, v7, v122, v125

    v_perm_b32 v6, v203, v193, s61
    v_perm_b32 v7, v203, v193, s62
    v_dot2_f32_bf16 v126, v6, v122, v126
    v_dot2_f32_bf16 v127, v7, v122, v127

    v_perm_b32 v6, v204, v194, s61
    v_perm_b32 v7, v204, v194, s62
    v_dot2_f32_bf16 v128, v6, v122, v128
    v_dot2_f32_bf16 v129, v7, v122, v129

    v_perm_b32 v6, v205, v195, s61
    v_perm_b32 v7, v205, v195, s62
    v_dot2_f32_bf16 v130, v6, v122, v130
    v_dot2_f32_bf16 v131, v7, v122, v131

    v_perm_b32 v6, v206, v196, s61
    v_perm_b32 v7, v206, v196, s62
    v_dot2_f32_bf16 v132, v6, v122, v132
    v_dot2_f32_bf16 v133, v7, v122, v133

    v_perm_b32 v6, v207, v197, s61
    v_perm_b32 v7, v207, v197, s62
    v_dot2_f32_bf16 v134, v6, v122, v134
    v_dot2_f32_bf16 v135, v7, v122, v135

    v_perm_b32 v6, v208, v198, s61
    v_perm_b32 v7, v208, v198, s62
    v_dot2_f32_bf16 v136, v6, v122, v136
    v_dot2_f32_bf16 v137, v7, v122, v137

    v_perm_b32 v6, v209, v199, s61
    v_perm_b32 v7, v209, v199, s62
    v_dot2_f32_bf16 v138, v6, v122, v138
    v_dot2_f32_bf16 v139, v7, v122, v139

    v_perm_b32 v6, v210, v200, s61
    v_perm_b32 v7, v210, v200, s62
    v_dot2_f32_bf16 v140, v6, v122, v140
    v_dot2_f32_bf16 v141, v7, v122, v141

    v_perm_b32 v6, v222, v212, s61
    v_perm_b32 v7, v222, v212, s62
    v_dot2_f32_bf16 v124, v6, v123, v124
    v_dot2_f32_bf16 v125, v7, v123, v125

    v_perm_b32 v6, v223, v213, s61
    v_perm_b32 v7, v223, v213, s62
    v_dot2_f32_bf16 v126, v6, v123, v126
    v_dot2_f32_bf16 v127, v7, v123, v127

    v_perm_b32 v6, v224, v214, s61
    v_perm_b32 v7, v224, v214, s62
    v_dot2_f32_bf16 v128, v6, v123, v128
    v_dot2_f32_bf16 v129, v7, v123, v129

    v_perm_b32 v6, v225, v215, s61
    v_perm_b32 v7, v225, v215, s62
    v_dot2_f32_bf16 v130, v6, v123, v130
    v_dot2_f32_bf16 v131, v7, v123, v131

    v_perm_b32 v6, v226, v216, s61
    v_perm_b32 v7, v226, v216, s62
    v_dot2_f32_bf16 v132, v6, v123, v132
    v_dot2_f32_bf16 v133, v7, v123, v133

    v_perm_b32 v6, v227, v217, s61
    v_perm_b32 v7, v227, v217, s62
    v_dot2_f32_bf16 v134, v6, v123, v134
    v_dot2_f32_bf16 v135, v7, v123, v135

    v_perm_b32 v6, v228, v218, s61
    v_perm_b32 v7, v228, v218, s62
    v_dot2_f32_bf16 v136, v6, v123, v136
    v_dot2_f32_bf16 v137, v7, v123, v137

    v_perm_b32 v6, v229, v219, s61
    v_perm_b32 v7, v229, v219, s62
    v_dot2_f32_bf16 v138, v6, v123, v138
    v_dot2_f32_bf16 v139, v7, v123, v139

    v_perm_b32 v6, v230, v220, s61
    v_perm_b32 v7, v230, v220, s62
    v_dot2_f32_bf16 v140, v6, v123, v140
    v_dot2_f32_bf16 v141, v7, v123, v141

    v_cvt_pk_bf16_f32 v241, v124, v125
    v_cvt_pk_bf16_f32 v242, v126, v127
    v_cvt_pk_bf16_f32 v243, v128, v129
    v_cvt_pk_bf16_f32 v244, v130, v131
    v_cvt_pk_bf16_f32 v245, v132, v133
    v_cvt_pk_bf16_f32 v246, v134, v135
    v_cvt_pk_bf16_f32 v247, v136, v137
    v_cvt_pk_bf16_f32 v248, v138, v139
    v_cvt_pk_bf16_f32 v249, v140, v141
    s_barrier
    s_mul_i32 s37, s3, 36
    v_mul_u32_u24 v2, 296, v0
    v_add_u32 v2, s37, v2

    ds_write_b32 v2, v232 offset:0
    ds_write_b32 v2, v233 offset:4
    ds_write_b32 v2, v234 offset:8
    ds_write_b32 v2, v235 offset:12
    ds_write_b32 v2, v236 offset:16
    ds_write_b32 v2, v237 offset:20
    ds_write_b32 v2, v238 offset:24
    ds_write_b32 v2, v239 offset:28
    ds_write_b32 v2, v240 offset:32
    ds_write_b32 v2, v241 offset:18944
    ds_write_b32 v2, v242 offset:18948
    ds_write_b32 v2, v243 offset:18952
    ds_write_b32 v2, v244 offset:18956
    ds_write_b32 v2, v245 offset:18960
    ds_write_b32 v2, v246 offset:18964
    ds_write_b32 v2, v247 offset:18968
    ds_write_b32 v2, v248 offset:18972
    ds_write_b32 v2, v249 offset:18976
    v_and_b32 v4, 7, v0
    v_lshrrev_b32 v5, 1, v4
    v_and_b32 v4, 1, v4
    v_lshrrev_b32 v6, 3, v0
    s_lshl_b32 s36, s3, 3
    v_add_u32 v6, s36, v6
    v_lshlrev_b32 v7, 4, v4
    v_lshl_add_u32 v7, v5, 2, v7
    s_and_b32 s36, s21, 1
    s_lshl_b32 s36, s36, 4
    v_subrev_u32 v7, s36, v7
    v_mul_u32_u24 v8, 296, v6
    v_lshl_add_u32 v8, v7, 1, v8
    s_lshl_b32 s36, s20, 7
    v_add_u32 v9, s36, v6
    v_lshlrev_b32 v9, 6, v9
    v_lshl_add_u32 v9, v5, 4, v9
    v_lshl_add_u32 v9, v4, 3, v9
    s_mul_i32 s36, s21, 9
    s_lshr_b32 s36, s36, 1
    s_add_u32 s36, s36, 144
    s_lshl_b32 s36, s36, 17
    v_mov_b32 v10, 0x7f000000
    v_cmp_gt_i32 vcc, 0, v7
    s_nop 1
    v_cndmask_b32 v11, v9, v10, vcc
    v_max_i32 v12, 0, v8
    v_add_u32 v13, 128, v7
    v_cmp_le_i32 vcc, 144, v13
    s_nop 1
    v_cndmask_b32 v13, v9, v10, vcc
    s_waitcnt lgkmcnt(0)
    s_barrier

    ds_read_b64 v[16:17], v12 offset:0
    ds_read_b64 v[18:19], v12 offset:18944
    ds_read_b64 v[20:21], v8 offset:64
    ds_read_b64 v[22:23], v8 offset:19008
    ds_read_b64 v[24:25], v8 offset:128
    ds_read_b64 v[26:27], v8 offset:19072
    ds_read_b64 v[28:29], v8 offset:192
    ds_read_b64 v[30:31], v8 offset:19136
    ds_read_b64 v[32:33], v8 offset:256
    ds_read_b64 v[34:35], v8 offset:19200
    s_waitcnt lgkmcnt(8)
    buffer_store_dwordx2 v[16:17], v11, s[16:19], s36 offen offset:0
    s_add_u32 s38, s36, 4096
    buffer_store_dwordx2 v[18:19], v11, s[16:19], s38 offen
    s_add_u32 s36, s36, 131072
    s_waitcnt lgkmcnt(6)
    buffer_store_dwordx2 v[20:21], v9, s[16:19], s36 offen offset:0
    s_add_u32 s38, s36, 4096
    buffer_store_dwordx2 v[22:23], v9, s[16:19], s38 offen
    s_add_u32 s36, s36, 131072
    s_waitcnt lgkmcnt(4)
    buffer_store_dwordx2 v[24:25], v9, s[16:19], s36 offen offset:0
    s_add_u32 s38, s36, 4096
    buffer_store_dwordx2 v[26:27], v9, s[16:19], s38 offen
    s_add_u32 s36, s36, 131072
    s_waitcnt lgkmcnt(2)
    buffer_store_dwordx2 v[28:29], v9, s[16:19], s36 offen offset:0
    s_add_u32 s38, s36, 4096
    buffer_store_dwordx2 v[30:31], v9, s[16:19], s38 offen
    s_add_u32 s36, s36, 131072
    s_waitcnt lgkmcnt(0)
    buffer_store_dwordx2 v[32:33], v13, s[16:19], s36 offen offset:0
    s_add_u32 s38, s36, 4096
    buffer_store_dwordx2 v[34:35], v13, s[16:19], s38 offen
    s_add_u32 s36, s36, 131072
    s_waitcnt vmcnt(0)
    s_endpgm
G1_END:
    s_endpgm
.globl g2_kernel
.p2align 8
.type g2_kernel,@function
g2_kernel:
    s_cmp_ge_u32 s2, 256
    s_cbranch_scc1 G2_END
    s_load_dwordx2 s[4:5], s[0:1], 72
    s_load_dwordx2 s[10:11], s[0:1], 0
    s_load_dwordx2 s[40:41], s[0:1], 56
    v_lshrrev_b32 v1, 6, v0
    v_and_b32 v0, 63, v0
    s_nop 0
    v_readfirstlane_b32 s3, v1
    s_and_b32 s20, s2, 7
    s_lshl_b32 s20, s20, 2
    s_lshr_b32 s21, s2, 3
    s_and_b32 s22, s21, 3
    s_add_u32 s20, s20, s22
    s_lshr_b32 s21, s21, 2
    s_waitcnt lgkmcnt(0)

    s_add_u32 s16, s4, 0x400000
    s_addc_u32 s17, s5, 0
    s_mov_b32 s18, 0x1440000
    s_mov_b32 s19, 0x00020000
    s_mul_i32 s36, s21, 746496
    s_add_u32 s24, s4, 0x2000000
    s_addc_u32 s25, s5, 0
    s_add_u32 s24, s24, s36
    s_addc_u32 s25, s25, 0
    s_mov_b32 s26, 746496
    s_mov_b32 s27, 0x00020000
    s_mov_b32 s44, s10
    s_mov_b32 s45, s11
    s_mov_b32 s46, 0x240000
    s_mov_b32 s47, 0x00020000
    s_mov_b32 s48, s40
    s_mov_b32 s49, s41
    s_mov_b32 s50, 0x240000
    s_mov_b32 s51, 0x00020000
    v_lshrrev_b32 v10, 2, v0
    v_and_b32 v11, 3, v0
    v_lshrrev_b32 v12, 4, v0
    v_sub_u32 v12, 4, v12
    v_and_b32 v12, 3, v12
    v_xor_b32 v11, v11, v12
    v_lshlrev_b32 v2, 6, v10
    v_lshl_add_u32 v2, v11, 4, v2
    s_lshl_b32 s52, s3, 17
    s_lshl_b32 s36, s20, 12
    s_add_u32 s52, s52, s36
    s_mul_i32 s53, s3, 4608
    s_mul_i32 s54, s3, 36864
    v_lshlrev_b32 v3, 4, v0
    v_add_u32 v7, 4096, v3
    v_mov_b32 v10, 0x7f000000
    v_cmp_gt_u32 vcc, 32, v0
    s_nop 1
    v_cndmask_b32 v7, v10, v7, vcc

    s_add_u32 m0, s54, 0
    s_nop 0
    buffer_load_dwordx4 v2, s[16:19], s52 offen lds
    buffer_load_dwordx4 v2, s[16:19], s52 offen offset:1024 lds
    buffer_load_dwordx4 v2, s[16:19], s52 offen offset:2048 lds
    buffer_load_dwordx4 v2, s[16:19], s52 offen offset:3072 lds
    s_add_u32 m0, s54, 4096
    s_add_u32 s52, s52, 524288
    buffer_load_dwordx4 v3, s[24:27], s53 offen lds
    buffer_load_dwordx4 v3, s[24:27], s53 offen offset:1024 lds
    buffer_load_dwordx4 v3, s[24:27], s53 offen offset:2048 lds
    buffer_load_dwordx4 v3, s[24:27], s53 offen offset:3072 lds
    s_add_u32 m0, s54, 8192
    s_nop 0
    buffer_load_dwordx4 v7, s[24:27], s53 offen lds
    s_add_u32 s53, s53, 18432

    v_and_b32 v10, 15, v0
    v_lshrrev_b32 v11, 2, v10
    v_sub_u32 v11, 4, v11
    v_and_b32 v11, 3, v11
    v_lshrrev_b32 v12, 4, v0
    v_xor_b32 v11, v11, v12
    v_lshlrev_b32 v8, 6, v10
    v_lshl_add_u32 v8, v11, 4, v8
    v_lshrrev_b32 v13, 2, v0
    v_and_b32 v13, 3, v13
    v_lshl_add_u32 v13, v12, 2, v13
    v_lshlrev_b32 v9, 5, v13
    v_and_b32 v14, 3, v0
    v_lshl_add_u32 v9, v14, 3, v9
    v_add_u32 v9, 4096, v9
    v_lshlrev_b32 v6, 4, v13
    v_lshl_add_u32 v6, v14, 3, v6
    v_add_u32 v6, 8192, v6
    v_add_u32 v8, s54, v8
    v_add_u32 v9, s54, v9
    v_add_u32 v6, s54, v6

    v_mov_b32 v64, 0
    v_mov_b32 v65, 0
    v_mov_b32 v66, 0
    v_mov_b32 v67, 0
    v_mov_b32 v68, 0
    v_mov_b32 v69, 0
    v_mov_b32 v70, 0
    v_mov_b32 v71, 0
    v_mov_b32 v72, 0
    v_mov_b32 v73, 0
    v_mov_b32 v74, 0
    v_mov_b32 v75, 0
    v_mov_b32 v76, 0
    v_mov_b32 v77, 0
    v_mov_b32 v78, 0
    v_mov_b32 v79, 0
    v_mov_b32 v80, 0
    v_mov_b32 v81, 0
    v_mov_b32 v82, 0
    v_mov_b32 v83, 0
    v_mov_b32 v84, 0
    v_mov_b32 v85, 0
    v_mov_b32 v86, 0
    v_mov_b32 v87, 0
    v_mov_b32 v88, 0
    v_mov_b32 v89, 0
    v_mov_b32 v90, 0
    v_mov_b32 v91, 0
    v_mov_b32 v92, 0
    v_mov_b32 v93, 0
    v_mov_b32 v94, 0
    v_mov_b32 v95, 0
    v_mov_b32 v96, 0
    v_mov_b32 v97, 0
    v_mov_b32 v98, 0
    v_mov_b32 v99, 0
    v_mov_b32 v100, 0
    v_mov_b32 v101, 0
    v_mov_b32 v102, 0
    v_mov_b32 v103, 0
    v_mov_b32 v104, 0
    v_mov_b32 v105, 0
    v_mov_b32 v106, 0
    v_mov_b32 v107, 0
    v_mov_b32 v108, 0
    v_mov_b32 v109, 0
    v_mov_b32 v110, 0
    v_mov_b32 v111, 0
    v_mov_b32 v112, 0
    v_mov_b32 v113, 0
    v_mov_b32 v114, 0
    v_mov_b32 v115, 0
    v_mov_b32 v116, 0
    v_mov_b32 v117, 0
    v_mov_b32 v118, 0
    v_mov_b32 v119, 0
    v_mov_b32 v120, 0
    v_mov_b32 v121, 0
    v_mov_b32 v122, 0
    v_mov_b32 v123, 0
    v_mov_b32 v124, 0
    v_mov_b32 v125, 0
    v_mov_b32 v126, 0
    v_mov_b32 v127, 0
    v_mov_b32 v128, 0
    v_mov_b32 v129, 0
    v_mov_b32 v130, 0
    v_mov_b32 v131, 0
    v_mov_b32 v132, 0
    v_mov_b32 v133, 0
    v_mov_b32 v134, 0
    v_mov_b32 v135, 0
    v_mov_b32 v136, 0
    v_mov_b32 v137, 0
    v_mov_b32 v138, 0
    v_mov_b32 v139, 0
    v_mov_b32 v140, 0
    v_mov_b32 v141, 0
    v_mov_b32 v142, 0
    v_mov_b32 v143, 0
    s_add_u32 m0, s54, 9216
    s_nop 0
    buffer_load_dwordx4 v2, s[16:19], s52 offen lds
    buffer_load_dwordx4 v2, s[16:19], s52 offen offset:1024 lds
    buffer_load_dwordx4 v2, s[16:19], s52 offen offset:2048 lds
    buffer_load_dwordx4 v2, s[16:19], s52 offen offset:3072 lds
    s_add_u32 m0, s54, 13312
    s_add_u32 s52, s52, 524288
    buffer_load_dwordx4 v3, s[24:27], s53 offen lds
    buffer_load_dwordx4 v3, s[24:27], s53 offen offset:1024 lds
    buffer_load_dwordx4 v3, s[24:27], s53 offen offset:2048 lds
    buffer_load_dwordx4 v3, s[24:27], s53 offen offset:3072 lds
    s_add_u32 m0, s54, 17408
    s_nop 0
    buffer_load_dwordx4 v7, s[24:27], s53 offen lds
    s_add_u32 s53, s53, 18432

    s_add_u32 m0, s54, 18432
    s_nop 0
    buffer_load_dwordx4 v2, s[16:19], s52 offen lds
    buffer_load_dwordx4 v2, s[16:19], s52 offen offset:1024 lds
    buffer_load_dwordx4 v2, s[16:19], s52 offen offset:2048 lds
    buffer_load_dwordx4 v2, s[16:19], s52 offen offset:3072 lds
    s_add_u32 m0, s54, 22528
    s_add_u32 s52, s52, 524288
    buffer_load_dwordx4 v3, s[24:27], s53 offen lds
    buffer_load_dwordx4 v3, s[24:27], s53 offen offset:1024 lds
    buffer_load_dwordx4 v3, s[24:27], s53 offen offset:2048 lds
    buffer_load_dwordx4 v3, s[24:27], s53 offen offset:3072 lds
    s_add_u32 m0, s54, 26624
    s_nop 0
    buffer_load_dwordx4 v7, s[24:27], s53 offen lds
    s_add_u32 s53, s53, 18432

    s_mov_b32 s34, 0
    s_waitcnt vmcnt(18)
G2_LOOP:
    s_waitcnt vmcnt(18)
    ds_read_b128 v[16:19], v8 offset:0
    ds_read_b128 v[20:23], v8 offset:1024
    ds_read_b128 v[24:27], v8 offset:2048
    ds_read_b128 v[28:31], v8 offset:3072
    ds_read_b64_tr_b16 v[32:33], v9 offset:0
    ds_read_b64_tr_b16 v[34:35], v9 offset:512
    ds_read_b64_tr_b16 v[36:37], v9 offset:1024
    ds_read_b64_tr_b16 v[38:39], v9 offset:1536
    ds_read_b64_tr_b16 v[40:41], v9 offset:2048
    ds_read_b64_tr_b16 v[42:43], v9 offset:2560
    ds_read_b64_tr_b16 v[44:45], v9 offset:3072
    ds_read_b64_tr_b16 v[46:47], v9 offset:3584
    ds_read_b64_tr_b16 v[48:49], v6 offset:0
    ds_read_b64_tr_b16 v[50:51], v6 offset:256
    s_add_u32 m0, s54, 27648
    s_nop 0
    buffer_load_dwordx4 v2, s[16:19], s52 offen lds
    buffer_load_dwordx4 v2, s[16:19], s52 offen offset:1024 lds
    buffer_load_dwordx4 v2, s[16:19], s52 offen offset:2048 lds
    buffer_load_dwordx4 v2, s[16:19], s52 offen offset:3072 lds
    s_add_u32 m0, s54, 31744
    s_add_u32 s52, s52, 524288
    buffer_load_dwordx4 v3, s[24:27], s53 offen lds
    buffer_load_dwordx4 v3, s[24:27], s53 offen offset:1024 lds
    buffer_load_dwordx4 v3, s[24:27], s53 offen offset:2048 lds
    buffer_load_dwordx4 v3, s[24:27], s53 offen offset:3072 lds
    s_add_u32 m0, s54, 35840
    s_nop 0
    buffer_load_dwordx4 v7, s[24:27], s53 offen lds
    s_add_u32 s53, s53, 18432

    s_waitcnt lgkmcnt(8)
    v_mfma_f32_16x16x32_bf16 v[64:67], v[32:35], v[16:19], v[64:67]
    v_mfma_f32_16x16x32_bf16 v[68:71], v[32:35], v[20:23], v[68:71]
    v_mfma_f32_16x16x32_bf16 v[72:75], v[32:35], v[24:27], v[72:75]
    v_mfma_f32_16x16x32_bf16 v[76:79], v[32:35], v[28:31], v[76:79]
    s_waitcnt lgkmcnt(6)
    v_mfma_f32_16x16x32_bf16 v[80:83], v[36:39], v[16:19], v[80:83]
    v_mfma_f32_16x16x32_bf16 v[84:87], v[36:39], v[20:23], v[84:87]
    v_mfma_f32_16x16x32_bf16 v[88:91], v[36:39], v[24:27], v[88:91]
    v_mfma_f32_16x16x32_bf16 v[92:95], v[36:39], v[28:31], v[92:95]
    s_waitcnt lgkmcnt(4)
    v_mfma_f32_16x16x32_bf16 v[96:99], v[40:43], v[16:19], v[96:99]
    v_mfma_f32_16x16x32_bf16 v[100:103], v[40:43], v[20:23], v[100:103]
    v_mfma_f32_16x16x32_bf16 v[104:107], v[40:43], v[24:27], v[104:107]
    v_mfma_f32_16x16x32_bf16 v[108:111], v[40:43], v[28:31], v[108:111]
    s_waitcnt lgkmcnt(2)
    v_mfma_f32_16x16x32_bf16 v[112:115], v[44:47], v[16:19], v[112:115]
    v_mfma_f32_16x16x32_bf16 v[116:119], v[44:47], v[20:23], v[116:119]
    v_mfma_f32_16x16x32_bf16 v[120:123], v[44:47], v[24:27], v[120:123]
    v_mfma_f32_16x16x32_bf16 v[124:127], v[44:47], v[28:31], v[124:127]
    s_waitcnt lgkmcnt(0)
    v_mfma_f32_16x16x32_bf16 v[128:131], v[48:51], v[16:19], v[128:131]
    v_mfma_f32_16x16x32_bf16 v[132:135], v[48:51], v[20:23], v[132:135]
    v_mfma_f32_16x16x32_bf16 v[136:139], v[48:51], v[24:27], v[136:139]
    v_mfma_f32_16x16x32_bf16 v[140:143], v[48:51], v[28:31], v[140:143]
    s_waitcnt vmcnt(18)
    ds_read_b128 v[16:19], v8 offset:9216
    ds_read_b128 v[20:23], v8 offset:10240
    ds_read_b128 v[24:27], v8 offset:11264
    ds_read_b128 v[28:31], v8 offset:12288
    ds_read_b64_tr_b16 v[32:33], v9 offset:9216
    ds_read_b64_tr_b16 v[34:35], v9 offset:9728
    ds_read_b64_tr_b16 v[36:37], v9 offset:10240
    ds_read_b64_tr_b16 v[38:39], v9 offset:10752
    ds_read_b64_tr_b16 v[40:41], v9 offset:11264
    ds_read_b64_tr_b16 v[42:43], v9 offset:11776
    ds_read_b64_tr_b16 v[44:45], v9 offset:12288
    ds_read_b64_tr_b16 v[46:47], v9 offset:12800
    ds_read_b64_tr_b16 v[48:49], v6 offset:9216
    ds_read_b64_tr_b16 v[50:51], v6 offset:9472
    s_add_u32 m0, s54, 0
    s_nop 0
    buffer_load_dwordx4 v2, s[16:19], s52 offen lds
    buffer_load_dwordx4 v2, s[16:19], s52 offen offset:1024 lds
    buffer_load_dwordx4 v2, s[16:19], s52 offen offset:2048 lds
    buffer_load_dwordx4 v2, s[16:19], s52 offen offset:3072 lds
    s_add_u32 m0, s54, 4096
    s_add_u32 s52, s52, 524288
    buffer_load_dwordx4 v3, s[24:27], s53 offen lds
    buffer_load_dwordx4 v3, s[24:27], s53 offen offset:1024 lds
    buffer_load_dwordx4 v3, s[24:27], s53 offen offset:2048 lds
    buffer_load_dwordx4 v3, s[24:27], s53 offen offset:3072 lds
    s_add_u32 m0, s54, 8192
    s_nop 0
    buffer_load_dwordx4 v7, s[24:27], s53 offen lds
    s_add_u32 s53, s53, 18432

    s_waitcnt lgkmcnt(8)
    v_mfma_f32_16x16x32_bf16 v[64:67], v[32:35], v[16:19], v[64:67]
    v_mfma_f32_16x16x32_bf16 v[68:71], v[32:35], v[20:23], v[68:71]
    v_mfma_f32_16x16x32_bf16 v[72:75], v[32:35], v[24:27], v[72:75]
    v_mfma_f32_16x16x32_bf16 v[76:79], v[32:35], v[28:31], v[76:79]
    s_waitcnt lgkmcnt(6)
    v_mfma_f32_16x16x32_bf16 v[80:83], v[36:39], v[16:19], v[80:83]
    v_mfma_f32_16x16x32_bf16 v[84:87], v[36:39], v[20:23], v[84:87]
    v_mfma_f32_16x16x32_bf16 v[88:91], v[36:39], v[24:27], v[88:91]
    v_mfma_f32_16x16x32_bf16 v[92:95], v[36:39], v[28:31], v[92:95]
    s_waitcnt lgkmcnt(4)
    v_mfma_f32_16x16x32_bf16 v[96:99], v[40:43], v[16:19], v[96:99]
    v_mfma_f32_16x16x32_bf16 v[100:103], v[40:43], v[20:23], v[100:103]
    v_mfma_f32_16x16x32_bf16 v[104:107], v[40:43], v[24:27], v[104:107]
    v_mfma_f32_16x16x32_bf16 v[108:111], v[40:43], v[28:31], v[108:111]
    s_waitcnt lgkmcnt(2)
    v_mfma_f32_16x16x32_bf16 v[112:115], v[44:47], v[16:19], v[112:115]
    v_mfma_f32_16x16x32_bf16 v[116:119], v[44:47], v[20:23], v[116:119]
    v_mfma_f32_16x16x32_bf16 v[120:123], v[44:47], v[24:27], v[120:123]
    v_mfma_f32_16x16x32_bf16 v[124:127], v[44:47], v[28:31], v[124:127]
    s_waitcnt lgkmcnt(0)
    v_mfma_f32_16x16x32_bf16 v[128:131], v[48:51], v[16:19], v[128:131]
    v_mfma_f32_16x16x32_bf16 v[132:135], v[48:51], v[20:23], v[132:135]
    v_mfma_f32_16x16x32_bf16 v[136:139], v[48:51], v[24:27], v[136:139]
    v_mfma_f32_16x16x32_bf16 v[140:143], v[48:51], v[28:31], v[140:143]
    s_waitcnt vmcnt(18)
    ds_read_b128 v[16:19], v8 offset:18432
    ds_read_b128 v[20:23], v8 offset:19456
    ds_read_b128 v[24:27], v8 offset:20480
    ds_read_b128 v[28:31], v8 offset:21504
    ds_read_b64_tr_b16 v[32:33], v9 offset:18432
    ds_read_b64_tr_b16 v[34:35], v9 offset:18944
    ds_read_b64_tr_b16 v[36:37], v9 offset:19456
    ds_read_b64_tr_b16 v[38:39], v9 offset:19968
    ds_read_b64_tr_b16 v[40:41], v9 offset:20480
    ds_read_b64_tr_b16 v[42:43], v9 offset:20992
    ds_read_b64_tr_b16 v[44:45], v9 offset:21504
    ds_read_b64_tr_b16 v[46:47], v9 offset:22016
    ds_read_b64_tr_b16 v[48:49], v6 offset:18432
    ds_read_b64_tr_b16 v[50:51], v6 offset:18688
    s_add_u32 m0, s54, 9216
    s_nop 0
    buffer_load_dwordx4 v2, s[16:19], s52 offen lds
    buffer_load_dwordx4 v2, s[16:19], s52 offen offset:1024 lds
    buffer_load_dwordx4 v2, s[16:19], s52 offen offset:2048 lds
    buffer_load_dwordx4 v2, s[16:19], s52 offen offset:3072 lds
    s_add_u32 m0, s54, 13312
    s_add_u32 s52, s52, 524288
    buffer_load_dwordx4 v3, s[24:27], s53 offen lds
    buffer_load_dwordx4 v3, s[24:27], s53 offen offset:1024 lds
    buffer_load_dwordx4 v3, s[24:27], s53 offen offset:2048 lds
    buffer_load_dwordx4 v3, s[24:27], s53 offen offset:3072 lds
    s_add_u32 m0, s54, 17408
    s_nop 0
    buffer_load_dwordx4 v7, s[24:27], s53 offen lds
    s_add_u32 s53, s53, 18432

    s_waitcnt lgkmcnt(8)
    v_mfma_f32_16x16x32_bf16 v[64:67], v[32:35], v[16:19], v[64:67]
    v_mfma_f32_16x16x32_bf16 v[68:71], v[32:35], v[20:23], v[68:71]
    v_mfma_f32_16x16x32_bf16 v[72:75], v[32:35], v[24:27], v[72:75]
    v_mfma_f32_16x16x32_bf16 v[76:79], v[32:35], v[28:31], v[76:79]
    s_waitcnt lgkmcnt(6)
    v_mfma_f32_16x16x32_bf16 v[80:83], v[36:39], v[16:19], v[80:83]
    v_mfma_f32_16x16x32_bf16 v[84:87], v[36:39], v[20:23], v[84:87]
    v_mfma_f32_16x16x32_bf16 v[88:91], v[36:39], v[24:27], v[88:91]
    v_mfma_f32_16x16x32_bf16 v[92:95], v[36:39], v[28:31], v[92:95]
    s_waitcnt lgkmcnt(4)
    v_mfma_f32_16x16x32_bf16 v[96:99], v[40:43], v[16:19], v[96:99]
    v_mfma_f32_16x16x32_bf16 v[100:103], v[40:43], v[20:23], v[100:103]
    v_mfma_f32_16x16x32_bf16 v[104:107], v[40:43], v[24:27], v[104:107]
    v_mfma_f32_16x16x32_bf16 v[108:111], v[40:43], v[28:31], v[108:111]
    s_waitcnt lgkmcnt(2)
    v_mfma_f32_16x16x32_bf16 v[112:115], v[44:47], v[16:19], v[112:115]
    v_mfma_f32_16x16x32_bf16 v[116:119], v[44:47], v[20:23], v[116:119]
    v_mfma_f32_16x16x32_bf16 v[120:123], v[44:47], v[24:27], v[120:123]
    v_mfma_f32_16x16x32_bf16 v[124:127], v[44:47], v[28:31], v[124:127]
    s_waitcnt lgkmcnt(0)
    v_mfma_f32_16x16x32_bf16 v[128:131], v[48:51], v[16:19], v[128:131]
    v_mfma_f32_16x16x32_bf16 v[132:135], v[48:51], v[20:23], v[132:135]
    v_mfma_f32_16x16x32_bf16 v[136:139], v[48:51], v[24:27], v[136:139]
    v_mfma_f32_16x16x32_bf16 v[140:143], v[48:51], v[28:31], v[140:143]
    s_waitcnt vmcnt(18)
    ds_read_b128 v[16:19], v8 offset:27648
    ds_read_b128 v[20:23], v8 offset:28672
    ds_read_b128 v[24:27], v8 offset:29696
    ds_read_b128 v[28:31], v8 offset:30720
    ds_read_b64_tr_b16 v[32:33], v9 offset:27648
    ds_read_b64_tr_b16 v[34:35], v9 offset:28160
    ds_read_b64_tr_b16 v[36:37], v9 offset:28672
    ds_read_b64_tr_b16 v[38:39], v9 offset:29184
    ds_read_b64_tr_b16 v[40:41], v9 offset:29696
    ds_read_b64_tr_b16 v[42:43], v9 offset:30208
    ds_read_b64_tr_b16 v[44:45], v9 offset:30720
    ds_read_b64_tr_b16 v[46:47], v9 offset:31232
    ds_read_b64_tr_b16 v[48:49], v6 offset:27648
    ds_read_b64_tr_b16 v[50:51], v6 offset:27904
    s_add_u32 m0, s54, 18432
    s_nop 0
    buffer_load_dwordx4 v2, s[16:19], s52 offen lds
    buffer_load_dwordx4 v2, s[16:19], s52 offen offset:1024 lds
    buffer_load_dwordx4 v2, s[16:19], s52 offen offset:2048 lds
    buffer_load_dwordx4 v2, s[16:19], s52 offen offset:3072 lds
    s_add_u32 m0, s54, 22528
    s_add_u32 s52, s52, 524288
    buffer_load_dwordx4 v3, s[24:27], s53 offen lds
    buffer_load_dwordx4 v3, s[24:27], s53 offen offset:1024 lds
    buffer_load_dwordx4 v3, s[24:27], s53 offen offset:2048 lds
    buffer_load_dwordx4 v3, s[24:27], s53 offen offset:3072 lds
    s_add_u32 m0, s54, 26624
    s_nop 0
    buffer_load_dwordx4 v7, s[24:27], s53 offen lds
    s_add_u32 s53, s53, 18432

    s_waitcnt lgkmcnt(8)
    v_mfma_f32_16x16x32_bf16 v[64:67], v[32:35], v[16:19], v[64:67]
    v_mfma_f32_16x16x32_bf16 v[68:71], v[32:35], v[20:23], v[68:71]
    v_mfma_f32_16x16x32_bf16 v[72:75], v[32:35], v[24:27], v[72:75]
    v_mfma_f32_16x16x32_bf16 v[76:79], v[32:35], v[28:31], v[76:79]
    s_waitcnt lgkmcnt(6)
    v_mfma_f32_16x16x32_bf16 v[80:83], v[36:39], v[16:19], v[80:83]
    v_mfma_f32_16x16x32_bf16 v[84:87], v[36:39], v[20:23], v[84:87]
    v_mfma_f32_16x16x32_bf16 v[88:91], v[36:39], v[24:27], v[88:91]
    v_mfma_f32_16x16x32_bf16 v[92:95], v[36:39], v[28:31], v[92:95]
    s_waitcnt lgkmcnt(4)
    v_mfma_f32_16x16x32_bf16 v[96:99], v[40:43], v[16:19], v[96:99]
    v_mfma_f32_16x16x32_bf16 v[100:103], v[40:43], v[20:23], v[100:103]
    v_mfma_f32_16x16x32_bf16 v[104:107], v[40:43], v[24:27], v[104:107]
    v_mfma_f32_16x16x32_bf16 v[108:111], v[40:43], v[28:31], v[108:111]
    s_waitcnt lgkmcnt(2)
    v_mfma_f32_16x16x32_bf16 v[112:115], v[44:47], v[16:19], v[112:115]
    v_mfma_f32_16x16x32_bf16 v[116:119], v[44:47], v[20:23], v[116:119]
    v_mfma_f32_16x16x32_bf16 v[120:123], v[44:47], v[24:27], v[120:123]
    v_mfma_f32_16x16x32_bf16 v[124:127], v[44:47], v[28:31], v[124:127]
    s_waitcnt lgkmcnt(0)
    v_mfma_f32_16x16x32_bf16 v[128:131], v[48:51], v[16:19], v[128:131]
    v_mfma_f32_16x16x32_bf16 v[132:135], v[48:51], v[20:23], v[132:135]
    v_mfma_f32_16x16x32_bf16 v[136:139], v[48:51], v[24:27], v[136:139]
    v_mfma_f32_16x16x32_bf16 v[140:143], v[48:51], v[28:31], v[140:143]
    s_add_u32 s34, s34, 1
    s_cmp_lt_u32 s34, 10
    s_cbranch_scc1 G2_LOOP

    s_waitcnt vmcnt(18)
    ds_read_b128 v[16:19], v8 offset:0
    ds_read_b128 v[20:23], v8 offset:1024
    ds_read_b128 v[24:27], v8 offset:2048
    ds_read_b128 v[28:31], v8 offset:3072
    ds_read_b64_tr_b16 v[32:33], v9 offset:0
    ds_read_b64_tr_b16 v[34:35], v9 offset:512
    ds_read_b64_tr_b16 v[36:37], v9 offset:1024
    ds_read_b64_tr_b16 v[38:39], v9 offset:1536
    ds_read_b64_tr_b16 v[40:41], v9 offset:2048
    ds_read_b64_tr_b16 v[42:43], v9 offset:2560
    ds_read_b64_tr_b16 v[44:45], v9 offset:3072
    ds_read_b64_tr_b16 v[46:47], v9 offset:3584
    ds_read_b64_tr_b16 v[48:49], v6 offset:0
    ds_read_b64_tr_b16 v[50:51], v6 offset:256
    s_add_u32 m0, s54, 27648
    s_nop 0
    buffer_load_dwordx4 v2, s[16:19], s52 offen lds
    buffer_load_dwordx4 v2, s[16:19], s52 offen offset:1024 lds
    buffer_load_dwordx4 v2, s[16:19], s52 offen offset:2048 lds
    buffer_load_dwordx4 v2, s[16:19], s52 offen offset:3072 lds
    s_add_u32 m0, s54, 31744
    s_add_u32 s52, s52, 524288
    buffer_load_dwordx4 v3, s[24:27], s53 offen lds
    buffer_load_dwordx4 v3, s[24:27], s53 offen offset:1024 lds
    buffer_load_dwordx4 v3, s[24:27], s53 offen offset:2048 lds
    buffer_load_dwordx4 v3, s[24:27], s53 offen offset:3072 lds
    s_add_u32 m0, s54, 35840
    s_nop 0
    buffer_load_dwordx4 v7, s[24:27], s53 offen lds
    s_add_u32 s53, s53, 18432

    s_waitcnt lgkmcnt(8)
    v_mfma_f32_16x16x32_bf16 v[64:67], v[32:35], v[16:19], v[64:67]
    v_mfma_f32_16x16x32_bf16 v[68:71], v[32:35], v[20:23], v[68:71]
    v_mfma_f32_16x16x32_bf16 v[72:75], v[32:35], v[24:27], v[72:75]
    v_mfma_f32_16x16x32_bf16 v[76:79], v[32:35], v[28:31], v[76:79]
    s_waitcnt lgkmcnt(6)
    v_mfma_f32_16x16x32_bf16 v[80:83], v[36:39], v[16:19], v[80:83]
    v_mfma_f32_16x16x32_bf16 v[84:87], v[36:39], v[20:23], v[84:87]
    v_mfma_f32_16x16x32_bf16 v[88:91], v[36:39], v[24:27], v[88:91]
    v_mfma_f32_16x16x32_bf16 v[92:95], v[36:39], v[28:31], v[92:95]
    s_waitcnt lgkmcnt(4)
    v_mfma_f32_16x16x32_bf16 v[96:99], v[40:43], v[16:19], v[96:99]
    v_mfma_f32_16x16x32_bf16 v[100:103], v[40:43], v[20:23], v[100:103]
    v_mfma_f32_16x16x32_bf16 v[104:107], v[40:43], v[24:27], v[104:107]
    v_mfma_f32_16x16x32_bf16 v[108:111], v[40:43], v[28:31], v[108:111]
    s_waitcnt lgkmcnt(2)
    v_mfma_f32_16x16x32_bf16 v[112:115], v[44:47], v[16:19], v[112:115]
    v_mfma_f32_16x16x32_bf16 v[116:119], v[44:47], v[20:23], v[116:119]
    v_mfma_f32_16x16x32_bf16 v[120:123], v[44:47], v[24:27], v[120:123]
    v_mfma_f32_16x16x32_bf16 v[124:127], v[44:47], v[28:31], v[124:127]
    s_waitcnt lgkmcnt(0)
    v_mfma_f32_16x16x32_bf16 v[128:131], v[48:51], v[16:19], v[128:131]
    v_mfma_f32_16x16x32_bf16 v[132:135], v[48:51], v[20:23], v[132:135]
    v_mfma_f32_16x16x32_bf16 v[136:139], v[48:51], v[24:27], v[136:139]
    v_mfma_f32_16x16x32_bf16 v[140:143], v[48:51], v[28:31], v[140:143]
    s_waitcnt vmcnt(0)
    s_barrier

    s_mul_i32 s36, s3, 20480
    v_lshlrev_b32 v10, 4, v0
    v_add_u32 v10, s36, v10
    s_nop 7

    ds_write_b128 v10, v[64:67] offset:0
    ds_write_b128 v10, v[68:71] offset:1024
    ds_write_b128 v10, v[72:75] offset:2048
    ds_write_b128 v10, v[76:79] offset:3072
    ds_write_b128 v10, v[80:83] offset:4096
    ds_write_b128 v10, v[84:87] offset:5120
    ds_write_b128 v10, v[88:91] offset:6144
    ds_write_b128 v10, v[92:95] offset:7168
    ds_write_b128 v10, v[96:99] offset:8192
    ds_write_b128 v10, v[100:103] offset:9216
    ds_write_b128 v10, v[104:107] offset:10240
    ds_write_b128 v10, v[108:111] offset:11264
    ds_write_b128 v10, v[112:115] offset:12288
    ds_write_b128 v10, v[116:119] offset:13312
    ds_write_b128 v10, v[120:123] offset:14336
    ds_write_b128 v10, v[124:127] offset:15360
    ds_write_b128 v10, v[128:131] offset:16384
    ds_write_b128 v10, v[132:135] offset:17408
    ds_write_b128 v10, v[136:139] offset:18432
    ds_write_b128 v10, v[140:143] offset:19456
    v_and_b32 v11, 15, v0
    s_lshl_b32 s36, s20, 6
    s_lshl_b32 s37, s3, 4
    s_add_u32 s36, s36, s37
    v_add_u32 v11, s36, v11
    v_mul_u32_u24 v11, 1152, v11
    v_lshrrev_b32 v12, 4, v0
    v_lshl_add_u32 v11, v12, 3, v11
    s_mul_i32 s36, s21, 144
    v_add_u32 v11, s36, v11
    v_add_u32 v13, 128, v11
    v_mov_b32 v14, 0x7f000000
    v_cmp_gt_u32 vcc, 32, v0
    s_nop 1
    v_cndmask_b32 v13, v14, v13, vcc

    buffer_load_dwordx2 v[16:17], v11, s[44:47], 0 offen offset:0
    buffer_load_dwordx2 v[18:19], v11, s[44:47], 0 offen offset:32
    buffer_load_dwordx2 v[20:21], v11, s[44:47], 0 offen offset:64
    buffer_load_dwordx2 v[22:23], v11, s[44:47], 0 offen offset:96
    buffer_load_dwordx2 v[24:25], v13, s[44:47], 0 offen
    s_waitcnt lgkmcnt(0)
    s_barrier
    s_lshl_b32 s36, s3, 10
    v_lshlrev_b32 v10, 4, v0
    v_add_u32 v10, s36, v10

    v_add_u32 v15, 40960, v10
    ds_read_b128 v[64:67], v10 offset:0
    ds_read_b128 v[68:71], v10 offset:20480
    ds_read_b128 v[72:75], v15 offset:0
    ds_read_b128 v[76:79], v15 offset:20480
    ds_read_b128 v[80:83], v10 offset:4096
    ds_read_b128 v[84:87], v10 offset:24576
    ds_read_b128 v[88:91], v15 offset:4096
    ds_read_b128 v[92:95], v15 offset:24576
    ds_read_b128 v[96:99], v10 offset:8192
    ds_read_b128 v[100:103], v10 offset:28672
    ds_read_b128 v[104:107], v15 offset:8192
    ds_read_b128 v[108:111], v15 offset:28672
    ds_read_b128 v[112:115], v10 offset:12288
    ds_read_b128 v[116:119], v10 offset:32768
    ds_read_b128 v[120:123], v15 offset:12288
    ds_read_b128 v[124:127], v15 offset:32768
    ds_read_b128 v[128:131], v10 offset:16384
    ds_read_b128 v[132:135], v10 offset:36864
    ds_read_b128 v[136:139], v15 offset:16384
    ds_read_b128 v[140:143], v15 offset:36864
    s_waitcnt vmcnt(0)
    s_waitcnt lgkmcnt(15)
    v_add_f32 v64, v64, v68
    v_add_f32 v72, v72, v76
    v_add_f32 v64, v64, v72
    v_add_f32 v65, v65, v69
    v_add_f32 v73, v73, v77
    v_add_f32 v65, v65, v73
    v_add_f32 v66, v66, v70
    v_add_f32 v74, v74, v78
    v_add_f32 v66, v66, v74
    v_add_f32 v67, v67, v71
    v_add_f32 v75, v75, v79
    v_add_f32 v67, v67, v75
    v_lshlrev_b32 v30, 16, v16
    v_and_b32 v31, 0xffff0000, v16
    v_lshlrev_b32 v32, 16, v17
    v_and_b32 v33, 0xffff0000, v17
    v_add_f32 v64, v64, v30
    v_add_f32 v65, v65, v31
    v_add_f32 v66, v66, v32
    v_add_f32 v67, v67, v33
    v_cvt_pk_bf16_f32 v34, v64, v65
    v_cvt_pk_bf16_f32 v35, v66, v67

    buffer_store_dwordx2 v[34:35], v11, s[48:51], 0 offen offset:0
    s_waitcnt lgkmcnt(12)
    v_add_f32 v80, v80, v84
    v_add_f32 v88, v88, v92
    v_add_f32 v80, v80, v88
    v_add_f32 v81, v81, v85
    v_add_f32 v89, v89, v93
    v_add_f32 v81, v81, v89
    v_add_f32 v82, v82, v86
    v_add_f32 v90, v90, v94
    v_add_f32 v82, v82, v90
    v_add_f32 v83, v83, v87
    v_add_f32 v91, v91, v95
    v_add_f32 v83, v83, v91
    v_lshlrev_b32 v30, 16, v18
    v_and_b32 v31, 0xffff0000, v18
    v_lshlrev_b32 v32, 16, v19
    v_and_b32 v33, 0xffff0000, v19
    v_add_f32 v80, v80, v30
    v_add_f32 v81, v81, v31
    v_add_f32 v82, v82, v32
    v_add_f32 v83, v83, v33
    v_cvt_pk_bf16_f32 v36, v80, v81
    v_cvt_pk_bf16_f32 v37, v82, v83

    buffer_store_dwordx2 v[36:37], v11, s[48:51], 0 offen offset:32
    s_waitcnt lgkmcnt(8)
    v_add_f32 v96, v96, v100
    v_add_f32 v104, v104, v108
    v_add_f32 v96, v96, v104
    v_add_f32 v97, v97, v101
    v_add_f32 v105, v105, v109
    v_add_f32 v97, v97, v105
    v_add_f32 v98, v98, v102
    v_add_f32 v106, v106, v110
    v_add_f32 v98, v98, v106
    v_add_f32 v99, v99, v103
    v_add_f32 v107, v107, v111
    v_add_f32 v99, v99, v107
    v_lshlrev_b32 v30, 16, v20
    v_and_b32 v31, 0xffff0000, v20
    v_lshlrev_b32 v32, 16, v21
    v_and_b32 v33, 0xffff0000, v21
    v_add_f32 v96, v96, v30
    v_add_f32 v97, v97, v31
    v_add_f32 v98, v98, v32
    v_add_f32 v99, v99, v33
    v_cvt_pk_bf16_f32 v38, v96, v97
    v_cvt_pk_bf16_f32 v39, v98, v99

    buffer_store_dwordx2 v[38:39], v11, s[48:51], 0 offen offset:64
    s_waitcnt lgkmcnt(4)
    v_add_f32 v112, v112, v116
    v_add_f32 v120, v120, v124
    v_add_f32 v112, v112, v120
    v_add_f32 v113, v113, v117
    v_add_f32 v121, v121, v125
    v_add_f32 v113, v113, v121
    v_add_f32 v114, v114, v118
    v_add_f32 v122, v122, v126
    v_add_f32 v114, v114, v122
    v_add_f32 v115, v115, v119
    v_add_f32 v123, v123, v127
    v_add_f32 v115, v115, v123
    v_lshlrev_b32 v30, 16, v22
    v_and_b32 v31, 0xffff0000, v22
    v_lshlrev_b32 v32, 16, v23
    v_and_b32 v33, 0xffff0000, v23
    v_add_f32 v112, v112, v30
    v_add_f32 v113, v113, v31
    v_add_f32 v114, v114, v32
    v_add_f32 v115, v115, v33
    v_cvt_pk_bf16_f32 v40, v112, v113
    v_cvt_pk_bf16_f32 v41, v114, v115

    buffer_store_dwordx2 v[40:41], v11, s[48:51], 0 offen offset:96
    s_waitcnt lgkmcnt(0)
    v_add_f32 v128, v128, v132
    v_add_f32 v136, v136, v140
    v_add_f32 v128, v128, v136
    v_add_f32 v129, v129, v133
    v_add_f32 v137, v137, v141
    v_add_f32 v129, v129, v137
    v_add_f32 v130, v130, v134
    v_add_f32 v138, v138, v142
    v_add_f32 v130, v130, v138
    v_add_f32 v131, v131, v135
    v_add_f32 v139, v139, v143
    v_add_f32 v131, v131, v139
    v_lshlrev_b32 v30, 16, v24
    v_and_b32 v31, 0xffff0000, v24
    v_lshlrev_b32 v32, 16, v25
    v_and_b32 v33, 0xffff0000, v25
    v_add_f32 v128, v128, v30
    v_add_f32 v129, v129, v31
    v_add_f32 v130, v130, v32
    v_add_f32 v131, v131, v33
    v_cvt_pk_bf16_f32 v42, v128, v129
    v_cvt_pk_bf16_f32 v43, v130, v131

    buffer_store_dwordx2 v[42:43], v13, s[48:51], 0 offen
    s_waitcnt vmcnt(0)
G2_END:
    s_endpgm
.section .rodata,"a"
.p2align 6
.amdhsa_kernel ln_kernel
  .amdhsa_next_free_vgpr 136
  .amdhsa_next_free_sgpr 102
  .amdhsa_accum_offset 136
  .amdhsa_group_segment_fixed_size 0
  .amdhsa_kernarg_size 80
  .amdhsa_user_sgpr_count 2
  .amdhsa_user_sgpr_kernarg_segment_ptr 1
  .amdhsa_system_sgpr_workgroup_id_x 1
.end_amdhsa_kernel
.p2align 6
.amdhsa_kernel g1_kernel
  .amdhsa_next_free_vgpr 256
  .amdhsa_next_free_sgpr 102
  .amdhsa_accum_offset 256
  .amdhsa_group_segment_fixed_size 0
  .amdhsa_kernarg_size 80
  .amdhsa_user_sgpr_count 2
  .amdhsa_user_sgpr_kernarg_segment_ptr 1
  .amdhsa_system_sgpr_workgroup_id_x 1
.end_amdhsa_kernel
.p2align 6
.amdhsa_kernel g2_kernel
  .amdhsa_next_free_vgpr 144
  .amdhsa_next_free_sgpr 102
  .amdhsa_accum_offset 144
  .amdhsa_group_segment_fixed_size 0
  .amdhsa_kernarg_size 80
  .amdhsa_user_sgpr_count 2
  .amdhsa_user_sgpr_kernarg_segment_ptr 1
  .amdhsa_system_sgpr_workgroup_id_x 1
.end_amdhsa_kernel
```
